```python
import torch

def _softmax(x, axis=-1):
    return torch.softmax(x, dim=axis)
def _gelu(x):
    return torch.nn.functional.gelu(x, approximate="tanh")
def _silu(x):
    return torch.nn.functional.silu(x)
def _sigmoid(x):
    return torch.sigmoid(x)
def _layernorm(x, axis=-1, eps=1e-5):
    m = x.mean(dim=axis, keepdim=True)
    v = x.var(dim=axis, keepdim=True, unbiased=False)
    return (x - m) / torch.sqrt(v + eps)
def _scatter_add(tgt, idx, src, axis=0):
    return tgt.clone().index_add_(axis, idx, src)
def _segment_sum(src, seg, n):
    out = torch.zeros((n,) + src.shape[1:], dtype=src.dtype)
    return out.index_add_(0, seg, src)
def _pad(x, pw):
    flat = tuple(v for pair in reversed(pw) for v in pair)
    return torch.nn.functional.pad(x, flat)

kernel_name = 'sequential_preLN__linear_kernel_hedgehog__geglu_ffn__prompt'

def setup_inputs():

    _w = (lambda a: (lambda t: t.to(torch.bfloat16) if t.is_floating_point() else t)(torch.as_tensor(a)))
    def _A_setup():
        B, S, D, H = 1, 2048, 640, 32
        Dh = D // H
        return {
            "x": _w((lambda *s: torch.randn(*s, dtype=torch.bfloat16) * 0.05)(B, S, D)),
            "wqkv": _w((lambda *s: torch.randn(*s, dtype=torch.bfloat16) * 0.2)(D, 3 * D)),
            "w_phi": _w((lambda *s: torch.randn(*s, dtype=torch.bfloat16) * 0.2)(H, Dh, Dh) * (Dh ** -0.5)),
            "wo": _w((lambda *s: torch.randn(*s, dtype=torch.bfloat16) * 0.05)(D, D)),
        }
    _A_in = _A_setup()

    def _B_setup():
        B, S, D, F = 1, 2048, 640, 1728
        return {
            "x": _w((lambda *s: torch.randn(*s, dtype=torch.bfloat16) * 0.05)(B, S, D)),
            "w_gate": _w((lambda *s: torch.randn(*s, dtype=torch.bfloat16) * 0.05)(D, F)),
            "w_up": _w((lambda *s: torch.randn(*s, dtype=torch.bfloat16) * 0.05)(D, F)),
            "w_down": _w((lambda *s: torch.randn(*s, dtype=torch.bfloat16) * 0.05)(F, D)),
        }
    _B_in = _B_setup()

    return {
        "A_x": _A_in["x"],
        "A_wqkv": _A_in["wqkv"],
        "A_w_phi": _A_in["w_phi"],
        "A_wo": _A_in["wo"],
        "B_x": _B_in["x"],
        "B_w_gate": _B_in["w_gate"],
        "B_w_up": _B_in["w_up"],
        "B_w_down": _B_in["w_down"],
    }

def reference(A_x, A_wqkv, A_w_phi, A_wo, B_x, B_w_gate, B_w_up, B_w_down):
    def _A_ref(x, wqkv, w_phi, wo):
        B, S, D = x.shape
        H = 32; Dh = D // H
        qkv = (lambda x, *d: x.permute(*d))((x @ wqkv).reshape(B, S, 3, H, Dh), 2, 0, 3, 1, 4)
        q, k, v = qkv[0], qkv[1], qkv[2]
        pq = torch.einsum("bhsd,hdf->bhsf", q, w_phi)
        pk = torch.einsum("bhsd,hdf->bhsf", k, w_phi)
        phi_q = torch.concatenate([_softmax(pq, axis=-1), _softmax(-pq, axis=-1)], axis=-1)
        phi_k = torch.concatenate([_softmax(pk, axis=-1), _softmax(-pk, axis=-1)], axis=-1)
        kv = torch.einsum("bhsf,bhsd->bhfd", phi_k, v)
        z  = torch.einsum("bhsf->bhf", phi_k)
        num = torch.einsum("bhqf,bhfd->bhqd", phi_q, kv)
        den = torch.einsum("bhqf,bhf->bhq", phi_q, z)[..., None] + 1e-6
        o = num / den
        return (lambda x, *d: x.permute(*d))(o, 0, 2, 1, 3).reshape(B, S, D) @ wo

    def _B_ref(x, w_gate, w_up, w_down):
        return (_gelu(x @ w_gate) * (x @ w_up)) @ w_down

    x = A_x
    h = x + _A_ref(_layernorm(x, axis=-1), A_wqkv, A_w_phi, A_wo)
    h2 = h + _B_ref(_layernorm(h, axis=-1), B_w_gate, B_w_up, B_w_down)
    return h2
```

```asm
; @launch kernel=p1_kernel grid=(256,1,1) block=(512,1,1) lds=163840
; @launch kernel=p2_kernel grid=(256,1,1) block=(256,1,1) lds=163840
; @launch kernel=p3_kernel grid=(256,1,1) block=(512,1,1) lds=163840
; @launch kernel=p4_kernel grid=(256,1,1) block=(512,1,1) lds=163840
.amdgcn_target "amdgcn-amd-amdhsa--gfx950"
.text
.globl p1_kernel
.p2align 8
.type p1_kernel,@function
p1_kernel:
s_cmp_ge_u32 s2, 256
s_cbranch_scc1 Lp1_exit
s_load_dwordx8 s[4:11], s[0:1], 0
s_load_dwordx8 s[12:19], s[0:1], 32
s_load_dwordx4 s[20:23], s[0:1], 64
s_load_dwordx2 s[24:25], s[0:1], 80
v_lshrrev_b32 v1, 6, v0
s_and_b32 s27, s2, 7
s_lshr_b32 s28, s2, 3
v_readfirstlane_b32 s26, v1
s_waitcnt lgkmcnt(0)
s_mov_b32 s32, s24
s_mov_b32 s33, s25
s_mov_b32 s34, 0x1600000
s_mov_b32 s35, 0x00020000
s_cmp_ge_u32 s28, 24
s_cbranch_scc1 Lp1_pack
s_lshr_b32 s60, s27, 1
s_and_b32 s66, s27, 1
s_cmp_ge_u32 s28, 16
s_cbranch_scc1 Lp1_q
s_mov_b32 s59, 0
s_lshl_b32 s61, s60, 2
s_lshr_b32 s67, s28, 2
s_add_u32 s61, s61, s67
s_lshl_b32 s62, s66, 2
s_and_b32 s67, s28, 3
s_add_u32 s62, s62, s67
s_branch Lp1_main
Lp1_q:
s_mov_b32 s59, 1
s_sub_u32 s67, s28, 16
s_lshl_b32 s61, s60, 2
s_lshr_b32 s68, s67, 1
s_add_u32 s61, s61, s68
s_lshl_b32 s62, s66, 1
s_and_b32 s68, s67, 1
s_add_u32 s62, s62, s68
Lp1_main:
s_cmp_ge_u32 s26, 4
s_cbranch_scc0 Lp1_cons
s_sub_u32 s26, s26, 4
s_mov_b32 s36, s4
s_mov_b32 s37, s5
s_mov_b32 s38, 0x280000
s_mov_b32 s39, 0x00020000
s_mov_b32 s40, s6
s_mov_b32 s41, s7
s_mov_b32 s42, 0x258000
s_mov_b32 s43, 0x00020000
v_and_b32 v1, 63, v0
v_lshrrev_b32 v14, 3, v1
v_and_b32 v32, 7, v1
v_xor_b32 v32, v32, v14
v_lshlrev_b32 v32, 4, v32
v_mul_u32_u24 v14, 1280, v14
v_add_u32 v2, v14, v32
s_lshl_b32 s60, s61, 7
s_lshl_b32 s52, s26, 5
s_add_u32 s60, s60, s52
s_mul_i32 s52, s60, 1280
s_lshl_b32 s55, s26, 12
s_add_u32 s55, s55, 12288
v_add_u32 v3, 9216, v2
v_add_u32 v4, 18432, v2
v_add_u32 v5, 27648, v2
s_add_u32 m0, s55, 0
s_nop 0
buffer_load_dwordx4 v2, s[36:39], s52 offen offset:0 lds
buffer_load_dwordx4 v3, s[36:39], s52 offen offset:1024 lds
buffer_load_dwordx4 v4, s[36:39], s52 offen offset:2048 lds
buffer_load_dwordx4 v5, s[36:39], s52 offen offset:3072 lds
s_add_u32 s52, s52, 128
s_mul_i32 s68, s62, 160
s_add_u32 s69, s68, 2560
s_add_u32 s68, s68, 1280
s_mul_i32 s70, s62, 320
s_add_u32 s71, s70, 160
s_cmp_eq_u32 s59, 0
s_cselect_b32 s68, s68, s70
s_cselect_b32 s69, s69, s71
s_and_b32 s66, s68, 63
s_and_b32 s67, s69, 63
s_sub_u32 s68, s68, s66
s_sub_u32 s69, s69, s67
s_and_b32 s70, s26, 1
s_mul_i32 s71, s70, 192
s_add_u32 s72, s71, 0
v_add_u32 v32, s72, v1
v_mul_u32_u24 v33, 5462, v32
v_lshrrev_b32 v33, 16, v33
v_mul_u32_u24 v34, 12, v33
v_sub_u32 v34, v32, v34
v_bfe_u32 v36, v33, 2, 1
v_lshlrev_b32 v36, 1, v36
v_xor_b32 v34, v34, v36
v_and_b32 v35, 0x13, v33
v_and_b32 v36, 4, v33
v_lshlrev_b32 v36, 1, v36
v_or_b32 v35, v35, v36
v_and_b32 v36, 8, v33
v_lshrrev_b32 v36, 1, v36
v_or_b32 v35, v35, v36
v_mul_u32_u24 v35, 3840, v35
v_lshlrev_b32 v34, 4, v34
v_add_u32 v6, v35, v34
s_add_u32 s72, s71, 64
v_add_u32 v32, s72, v1
v_mul_u32_u24 v33, 5462, v32
v_lshrrev_b32 v33, 16, v33
v_mul_u32_u24 v34, 12, v33
v_sub_u32 v34, v32, v34
v_bfe_u32 v36, v33, 2, 1
v_lshlrev_b32 v36, 1, v36
v_xor_b32 v34, v34, v36
v_and_b32 v35, 0x13, v33
v_and_b32 v36, 4, v33
v_lshlrev_b32 v36, 1, v36
v_or_b32 v35, v35, v36
v_and_b32 v36, 8, v33
v_lshrrev_b32 v36, 1, v36
v_or_b32 v35, v35, v36
v_mul_u32_u24 v35, 3840, v35
v_lshlrev_b32 v34, 4, v34
v_add_u32 v7, v35, v34
v_subrev_u32 v7, 1024, v7
s_add_u32 s72, s71, 128
v_add_u32 v32, s72, v1
v_mul_u32_u24 v33, 5462, v32
v_lshrrev_b32 v33, 16, v33
v_mul_u32_u24 v34, 12, v33
v_sub_u32 v34, v32, v34
v_bfe_u32 v36, v33, 2, 1
v_lshlrev_b32 v36, 1, v36
v_xor_b32 v34, v34, v36
v_and_b32 v35, 0x13, v33
v_and_b32 v36, 4, v33
v_lshlrev_b32 v36, 1, v36
v_or_b32 v35, v35, v36
v_and_b32 v36, 8, v33
v_lshrrev_b32 v36, 1, v36
v_or_b32 v35, v35, v36
v_mul_u32_u24 v35, 3840, v35
v_lshlrev_b32 v34, 4, v34
v_add_u32 v8, v35, v34
v_subrev_u32 v8, 2048, v8
s_lshr_b32 s71, s26, 1
s_cmp_eq_u32 s71, 0
s_cselect_b32 s53, s68, s69
s_mul_i32 s56, s71, 6144
s_mul_i32 s72, s70, 3072
s_add_u32 s56, s56, s72
s_add_u32 s56, s56, 77824
s_add_u32 m0, s56, 0
s_nop 0
buffer_load_dwordx4 v6, s[40:43], s53 offen offset:0 lds
buffer_load_dwordx4 v7, s[40:43], s53 offen offset:1024 lds
buffer_load_dwordx4 v8, s[40:43], s53 offen offset:2048 lds
s_add_u32 s53, s53, 122880
s_add_u32 m0, s56, 12288
s_nop 0
buffer_load_dwordx4 v6, s[40:43], s53 offen offset:0 lds
buffer_load_dwordx4 v7, s[40:43], s53 offen offset:1024 lds
buffer_load_dwordx4 v8, s[40:43], s53 offen offset:2048 lds
s_add_u32 s53, s53, 122880
s_mov_b32 s44, s8
s_mov_b32 s45, s9
s_mov_b32 s46, 0x6400
s_mov_b32 s47, 0x00020000
s_mul_i32 s68, s62, 3200
s_mul_i32 s69, s62, 6400
s_cmp_eq_u32 s59, 0
s_cselect_b32 s68, s68, s69
s_lshl_b32 s69, s26, 11
s_add_u32 s68, s68, s69
s_add_u32 m0, s69, 0
v_lshlrev_b32 v14, 4, v1
buffer_load_dwordx4 v14, s[44:47], s68 offen lds
buffer_load_dwordx4 v14, s[44:47], s68 offen offset:1024 lds
s_add_u32 m0, s55, 16384
s_nop 0
buffer_load_dwordx4 v2, s[36:39], s52 offen offset:0 lds
buffer_load_dwordx4 v3, s[36:39], s52 offen offset:1024 lds
buffer_load_dwordx4 v4, s[36:39], s52 offen offset:2048 lds
buffer_load_dwordx4 v5, s[36:39], s52 offen offset:3072 lds
s_add_u32 s52, s52, 128
s_add_u32 m0, s56, 24576
s_nop 0
buffer_load_dwordx4 v6, s[40:43], s53 offen offset:0 lds
buffer_load_dwordx4 v7, s[40:43], s53 offen offset:1024 lds
buffer_load_dwordx4 v8, s[40:43], s53 offen offset:2048 lds
s_add_u32 s53, s53, 122880
s_add_u32 m0, s56, 36864
s_nop 0
buffer_load_dwordx4 v6, s[40:43], s53 offen offset:0 lds
buffer_load_dwordx4 v7, s[40:43], s53 offen offset:1024 lds
buffer_load_dwordx4 v8, s[40:43], s53 offen offset:2048 lds
s_add_u32 s53, s53, 122880
s_add_u32 m0, s55, 32768
s_nop 0
buffer_load_dwordx4 v2, s[36:39], s52 offen offset:0 lds
buffer_load_dwordx4 v3, s[36:39], s52 offen offset:1024 lds
buffer_load_dwordx4 v4, s[36:39], s52 offen offset:2048 lds
buffer_load_dwordx4 v5, s[36:39], s52 offen offset:3072 lds
s_add_u32 s52, s52, 128
s_add_u32 m0, s56, 49152
s_nop 0
buffer_load_dwordx4 v6, s[40:43], s53 offen offset:0 lds
buffer_load_dwordx4 v7, s[40:43], s53 offen offset:1024 lds
buffer_load_dwordx4 v8, s[40:43], s53 offen offset:2048 lds
s_add_u32 s53, s53, 122880
s_add_u32 m0, s56, 61440
s_nop 0
buffer_load_dwordx4 v6, s[40:43], s53 offen offset:0 lds
buffer_load_dwordx4 v7, s[40:43], s53 offen offset:1024 lds
buffer_load_dwordx4 v8, s[40:43], s53 offen offset:2048 lds
s_add_u32 s53, s53, 122880
v_and_b32 v232, 15, v1
v_lshrrev_b32 v233, 4, v1
v_and_b32 v234, 7, v232
v_xor_b32 v234, v234, v233
v_lshlrev_b32 v234, 4, v234
v_lshlrev_b32 v235, 7, v232
v_add_u32 v234, v234, v235
v_add_u32 v26, s55, v234
v_xor_b32 v27, 64, v26
s_mul_i32 s68, s62, 160
s_add_u32 s69, s68, 2560
s_add_u32 s68, s68, 1280
s_mul_i32 s70, s62, 320
s_add_u32 s71, s70, 160
s_cmp_eq_u32 s59, 0
s_cselect_b32 s68, s68, s70
s_cselect_b32 s69, s69, s71
s_and_b32 s66, s68, 63
s_and_b32 s67, s69, 63
s_sub_u32 s68, s68, s66
s_sub_u32 s69, s69, s67
s_cmp_eq_u32 s71, 0
s_lshr_b32 s72, s26, 1
s_cmp_eq_u32 s72, 0
s_cselect_b32 s73, s66, s67
s_mul_i32 s72, s72, 6144
s_add_u32 s72, s72, 77824
v_bfe_u32 v234, v1, 2, 2
v_and_b32 v235, 1, v233
v_lshlrev_b32 v236, 2, v235
v_add_u32 v234, v234, v236
v_lshrrev_b32 v236, 1, v233
v_lshlrev_b32 v236, 4, v236
v_add_u32 v234, v234, v236
v_mul_u32_u24 v234, 192, v234
v_add_u32 v234, s72, v234
v_lshlrev_b32 v235, 5, v235
v_and_b32 v236, 3, v1
v_mul_u32_u24 v236, 40, v236
v_add_u32 v237, s73, v236
v_add_u32 v238, 0, v237
v_xor_b32 v238, v238, v235
v_add_u32 v16, v238, v234
v_add_u32 v238, 8, v237
v_xor_b32 v238, v238, v235
v_add_u32 v17, v238, v234
v_add_u32 v238, 16, v237
v_xor_b32 v238, v238, v235
v_add_u32 v18, v238, v234
v_add_u32 v238, 24, v237
v_xor_b32 v238, v238, v235
v_add_u32 v19, v238, v234
v_add_u32 v238, 32, v237
v_xor_b32 v238, v238, v235
v_add_u32 v20, v238, v234
v_mov_b32 v28, 0x3f803f80
v_mov_b32 v29, 0x3f803f80
v_mov_b32 v30, 0x3f803f80
v_mov_b32 v31, 0x3f803f80
v_mov_b32 v32, 0
v_mov_b32 v33, 0
v_mov_b32 v34, 0
v_mov_b32 v35, 0
v_mov_b32 v36, 0
v_mov_b32 v37, 0
v_mov_b32 v38, 0
v_mov_b32 v39, 0
v_mov_b32 v40, 0
v_mov_b32 v41, 0
v_mov_b32 v42, 0
v_mov_b32 v43, 0
v_mov_b32 v44, 0
v_mov_b32 v45, 0
v_mov_b32 v46, 0
v_mov_b32 v47, 0
v_mov_b32 v48, 0
v_mov_b32 v49, 0
v_mov_b32 v50, 0
v_mov_b32 v51, 0
v_mov_b32 v52, 0
v_mov_b32 v53, 0
v_mov_b32 v54, 0
v_mov_b32 v55, 0
v_mov_b32 v56, 0
v_mov_b32 v57, 0
v_mov_b32 v58, 0
v_mov_b32 v59, 0
v_mov_b32 v60, 0
v_mov_b32 v61, 0
v_mov_b32 v62, 0
v_mov_b32 v63, 0
v_mov_b32 v64, 0
v_mov_b32 v65, 0
v_mov_b32 v66, 0
v_mov_b32 v67, 0
s_and_b32 s74, s26, 1
s_waitcnt vmcnt(22)
s_barrier
s_add_u32 m0, s55, 49152
s_nop 0
buffer_load_dwordx4 v2, s[36:39], s52 offen offset:0 lds
buffer_load_dwordx4 v3, s[36:39], s52 offen offset:1024 lds
buffer_load_dwordx4 v4, s[36:39], s52 offen offset:2048 lds
buffer_load_dwordx4 v5, s[36:39], s52 offen offset:3072 lds
s_add_u32 s52, s52, 128
s_add_u32 m0, s56, 73728
s_nop 0
buffer_load_dwordx4 v6, s[40:43], s53 offen offset:0 lds
buffer_load_dwordx4 v7, s[40:43], s53 offen offset:1024 lds
buffer_load_dwordx4 v8, s[40:43], s53 offen offset:2048 lds
s_add_u32 s53, s53, 122880
s_mov_b32 s75, 0
s_cmp_eq_u32 s74, 0
s_cselect_b32 s75, s75, 12288
ds_read_b128 v[88:91], v26 offset:0
ds_read_b128 v[92:95], v26 offset:2048
ds_read_b128 v[96:99], v27 offset:0
ds_read_b128 v[100:103], v27 offset:2048
v_add_u32 v21, s75, v16
v_add_u32 v22, s75, v17
v_add_u32 v23, s75, v18
v_add_u32 v24, s75, v19
v_add_u32 v25, s75, v20
ds_read_b64_tr_b16 v[68:69], v21
ds_read_b64_tr_b16 v[70:71], v21 offset:1536
ds_read_b64_tr_b16 v[72:73], v22
ds_read_b64_tr_b16 v[74:75], v22 offset:1536
ds_read_b64_tr_b16 v[76:77], v23
ds_read_b64_tr_b16 v[78:79], v23 offset:1536
ds_read_b64_tr_b16 v[80:81], v24
ds_read_b64_tr_b16 v[82:83], v24 offset:1536
ds_read_b64_tr_b16 v[84:85], v25
ds_read_b64_tr_b16 v[86:87], v25 offset:1536
s_waitcnt lgkmcnt(10)
v_mfma_f32_16x16x32_bf16 v[52:55], v[28:31], v[88:91], v[52:55]
v_mfma_f32_16x16x32_bf16 v[60:63], v[88:91], v[88:91], v[60:63]
v_mfma_f32_16x16x32_bf16 v[56:59], v[28:31], v[92:95], v[56:59]
v_mfma_f32_16x16x32_bf16 v[64:67], v[92:95], v[92:95], v[64:67]
v_mfma_f32_16x16x32_bf16 v[52:55], v[28:31], v[96:99], v[52:55]
v_mfma_f32_16x16x32_bf16 v[60:63], v[96:99], v[96:99], v[60:63]
v_mfma_f32_16x16x32_bf16 v[56:59], v[28:31], v[100:103], v[56:59]
v_mfma_f32_16x16x32_bf16 v[64:67], v[100:103], v[100:103], v[64:67]
s_waitcnt lgkmcnt(0)
v_mfma_f32_16x16x32_bf16 v[32:35], v[68:71], v[28:31], v[32:35]
v_mfma_f32_16x16x32_bf16 v[36:39], v[72:75], v[28:31], v[36:39]
v_mfma_f32_16x16x32_bf16 v[40:43], v[76:79], v[28:31], v[40:43]
v_mfma_f32_16x16x32_bf16 v[44:47], v[80:83], v[28:31], v[44:47]
v_mfma_f32_16x16x32_bf16 v[48:51], v[84:87], v[28:31], v[48:51]
s_waitcnt vmcnt(17)
s_barrier
s_add_u32 m0, s56, 0
s_nop 0
buffer_load_dwordx4 v6, s[40:43], s53 offen offset:0 lds
buffer_load_dwordx4 v7, s[40:43], s53 offen offset:1024 lds
buffer_load_dwordx4 v8, s[40:43], s53 offen offset:2048 lds
s_add_u32 s53, s53, 122880
s_add_u32 m0, s55, 0
s_nop 0
buffer_load_dwordx4 v2, s[36:39], s52 offen offset:0 lds
buffer_load_dwordx4 v3, s[36:39], s52 offen offset:1024 lds
buffer_load_dwordx4 v4, s[36:39], s52 offen offset:2048 lds
buffer_load_dwordx4 v5, s[36:39], s52 offen offset:3072 lds
s_add_u32 s52, s52, 128
s_add_u32 m0, s56, 12288
s_nop 0
buffer_load_dwordx4 v6, s[40:43], s53 offen offset:0 lds
buffer_load_dwordx4 v7, s[40:43], s53 offen offset:1024 lds
buffer_load_dwordx4 v8, s[40:43], s53 offen offset:2048 lds
s_add_u32 s53, s53, 122880
s_mov_b32 s75, 24576
s_cmp_eq_u32 s74, 0
s_cselect_b32 s75, s75, 36864
ds_read_b128 v[88:91], v26 offset:16384
ds_read_b128 v[92:95], v26 offset:18432
ds_read_b128 v[96:99], v27 offset:16384
ds_read_b128 v[100:103], v27 offset:18432
v_add_u32 v21, s75, v16
v_add_u32 v22, s75, v17
v_add_u32 v23, s75, v18
v_add_u32 v24, s75, v19
v_add_u32 v25, s75, v20
ds_read_b64_tr_b16 v[68:69], v21
ds_read_b64_tr_b16 v[70:71], v21 offset:1536
ds_read_b64_tr_b16 v[72:73], v22
ds_read_b64_tr_b16 v[74:75], v22 offset:1536
ds_read_b64_tr_b16 v[76:77], v23
ds_read_b64_tr_b16 v[78:79], v23 offset:1536
ds_read_b64_tr_b16 v[80:81], v24
ds_read_b64_tr_b16 v[82:83], v24 offset:1536
ds_read_b64_tr_b16 v[84:85], v25
ds_read_b64_tr_b16 v[86:87], v25 offset:1536
s_waitcnt lgkmcnt(10)
v_mfma_f32_16x16x32_bf16 v[52:55], v[28:31], v[88:91], v[52:55]
v_mfma_f32_16x16x32_bf16 v[60:63], v[88:91], v[88:91], v[60:63]
v_mfma_f32_16x16x32_bf16 v[56:59], v[28:31], v[92:95], v[56:59]
v_mfma_f32_16x16x32_bf16 v[64:67], v[92:95], v[92:95], v[64:67]
v_mfma_f32_16x16x32_bf16 v[52:55], v[28:31], v[96:99], v[52:55]
v_mfma_f32_16x16x32_bf16 v[60:63], v[96:99], v[96:99], v[60:63]
v_mfma_f32_16x16x32_bf16 v[56:59], v[28:31], v[100:103], v[56:59]
v_mfma_f32_16x16x32_bf16 v[64:67], v[100:103], v[100:103], v[64:67]
s_waitcnt lgkmcnt(0)
v_mfma_f32_16x16x32_bf16 v[32:35], v[68:71], v[28:31], v[32:35]
v_mfma_f32_16x16x32_bf16 v[36:39], v[72:75], v[28:31], v[36:39]
v_mfma_f32_16x16x32_bf16 v[40:43], v[76:79], v[28:31], v[40:43]
v_mfma_f32_16x16x32_bf16 v[44:47], v[80:83], v[28:31], v[44:47]
v_mfma_f32_16x16x32_bf16 v[48:51], v[84:87], v[28:31], v[48:51]
s_waitcnt vmcnt(17)
s_barrier
s_add_u32 m0, s56, 24576
s_nop 0
buffer_load_dwordx4 v6, s[40:43], s53 offen offset:0 lds
buffer_load_dwordx4 v7, s[40:43], s53 offen offset:1024 lds
buffer_load_dwordx4 v8, s[40:43], s53 offen offset:2048 lds
s_add_u32 s53, s53, 122880
s_add_u32 m0, s55, 16384
s_nop 0
buffer_load_dwordx4 v2, s[36:39], s52 offen offset:0 lds
buffer_load_dwordx4 v3, s[36:39], s52 offen offset:1024 lds
buffer_load_dwordx4 v4, s[36:39], s52 offen offset:2048 lds
buffer_load_dwordx4 v5, s[36:39], s52 offen offset:3072 lds
s_add_u32 s52, s52, 128
s_add_u32 m0, s56, 36864
s_nop 0
buffer_load_dwordx4 v6, s[40:43], s53 offen offset:0 lds
buffer_load_dwordx4 v7, s[40:43], s53 offen offset:1024 lds
buffer_load_dwordx4 v8, s[40:43], s53 offen offset:2048 lds
s_add_u32 s53, s53, 122880
s_mov_b32 s75, 49152
s_cmp_eq_u32 s74, 0
s_cselect_b32 s75, s75, 61440
ds_read_b128 v[88:91], v26 offset:32768
ds_read_b128 v[92:95], v26 offset:34816
ds_read_b128 v[96:99], v27 offset:32768
ds_read_b128 v[100:103], v27 offset:34816
v_add_u32 v21, s75, v16
v_add_u32 v22, s75, v17
v_add_u32 v23, s75, v18
v_add_u32 v24, s75, v19
v_add_u32 v25, s75, v20
ds_read_b64_tr_b16 v[68:69], v21
ds_read_b64_tr_b16 v[70:71], v21 offset:1536
ds_read_b64_tr_b16 v[72:73], v22
ds_read_b64_tr_b16 v[74:75], v22 offset:1536
ds_read_b64_tr_b16 v[76:77], v23
ds_read_b64_tr_b16 v[78:79], v23 offset:1536
ds_read_b64_tr_b16 v[80:81], v24
ds_read_b64_tr_b16 v[82:83], v24 offset:1536
ds_read_b64_tr_b16 v[84:85], v25
ds_read_b64_tr_b16 v[86:87], v25 offset:1536
s_waitcnt lgkmcnt(10)
v_mfma_f32_16x16x32_bf16 v[52:55], v[28:31], v[88:91], v[52:55]
v_mfma_f32_16x16x32_bf16 v[60:63], v[88:91], v[88:91], v[60:63]
v_mfma_f32_16x16x32_bf16 v[56:59], v[28:31], v[92:95], v[56:59]
v_mfma_f32_16x16x32_bf16 v[64:67], v[92:95], v[92:95], v[64:67]
v_mfma_f32_16x16x32_bf16 v[52:55], v[28:31], v[96:99], v[52:55]
v_mfma_f32_16x16x32_bf16 v[60:63], v[96:99], v[96:99], v[60:63]
v_mfma_f32_16x16x32_bf16 v[56:59], v[28:31], v[100:103], v[56:59]
v_mfma_f32_16x16x32_bf16 v[64:67], v[100:103], v[100:103], v[64:67]
s_waitcnt lgkmcnt(0)
v_mfma_f32_16x16x32_bf16 v[32:35], v[68:71], v[28:31], v[32:35]
v_mfma_f32_16x16x32_bf16 v[36:39], v[72:75], v[28:31], v[36:39]
v_mfma_f32_16x16x32_bf16 v[40:43], v[76:79], v[28:31], v[40:43]
v_mfma_f32_16x16x32_bf16 v[44:47], v[80:83], v[28:31], v[44:47]
v_mfma_f32_16x16x32_bf16 v[48:51], v[84:87], v[28:31], v[48:51]
s_waitcnt vmcnt(17)
s_barrier
s_add_u32 m0, s56, 49152
s_nop 0
buffer_load_dwordx4 v6, s[40:43], s53 offen offset:0 lds
buffer_load_dwordx4 v7, s[40:43], s53 offen offset:1024 lds
buffer_load_dwordx4 v8, s[40:43], s53 offen offset:2048 lds
s_add_u32 s53, s53, 122880
s_add_u32 m0, s55, 32768
s_nop 0
buffer_load_dwordx4 v2, s[36:39], s52 offen offset:0 lds
buffer_load_dwordx4 v3, s[36:39], s52 offen offset:1024 lds
buffer_load_dwordx4 v4, s[36:39], s52 offen offset:2048 lds
buffer_load_dwordx4 v5, s[36:39], s52 offen offset:3072 lds
s_add_u32 s52, s52, 128
s_add_u32 m0, s56, 61440
s_nop 0
buffer_load_dwordx4 v6, s[40:43], s53 offen offset:0 lds
buffer_load_dwordx4 v7, s[40:43], s53 offen offset:1024 lds
buffer_load_dwordx4 v8, s[40:43], s53 offen offset:2048 lds
s_add_u32 s53, s53, 122880
s_mov_b32 s75, 73728
s_cmp_eq_u32 s74, 0
s_cselect_b32 s75, s75, 0
ds_read_b128 v[88:91], v26 offset:49152
ds_read_b128 v[92:95], v26 offset:51200
ds_read_b128 v[96:99], v27 offset:49152
ds_read_b128 v[100:103], v27 offset:51200
v_add_u32 v21, s75, v16
v_add_u32 v22, s75, v17
v_add_u32 v23, s75, v18
v_add_u32 v24, s75, v19
v_add_u32 v25, s75, v20
ds_read_b64_tr_b16 v[68:69], v21
ds_read_b64_tr_b16 v[70:71], v21 offset:1536
ds_read_b64_tr_b16 v[72:73], v22
ds_read_b64_tr_b16 v[74:75], v22 offset:1536
ds_read_b64_tr_b16 v[76:77], v23
ds_read_b64_tr_b16 v[78:79], v23 offset:1536
ds_read_b64_tr_b16 v[80:81], v24
ds_read_b64_tr_b16 v[82:83], v24 offset:1536
ds_read_b64_tr_b16 v[84:85], v25
ds_read_b64_tr_b16 v[86:87], v25 offset:1536
s_waitcnt lgkmcnt(10)
v_mfma_f32_16x16x32_bf16 v[52:55], v[28:31], v[88:91], v[52:55]
v_mfma_f32_16x16x32_bf16 v[60:63], v[88:91], v[88:91], v[60:63]
v_mfma_f32_16x16x32_bf16 v[56:59], v[28:31], v[92:95], v[56:59]
v_mfma_f32_16x16x32_bf16 v[64:67], v[92:95], v[92:95], v[64:67]
v_mfma_f32_16x16x32_bf16 v[52:55], v[28:31], v[96:99], v[52:55]
v_mfma_f32_16x16x32_bf16 v[60:63], v[96:99], v[96:99], v[60:63]
v_mfma_f32_16x16x32_bf16 v[56:59], v[28:31], v[100:103], v[56:59]
v_mfma_f32_16x16x32_bf16 v[64:67], v[100:103], v[100:103], v[64:67]
s_waitcnt lgkmcnt(0)
v_mfma_f32_16x16x32_bf16 v[32:35], v[68:71], v[28:31], v[32:35]
v_mfma_f32_16x16x32_bf16 v[36:39], v[72:75], v[28:31], v[36:39]
v_mfma_f32_16x16x32_bf16 v[40:43], v[76:79], v[28:31], v[40:43]
v_mfma_f32_16x16x32_bf16 v[44:47], v[80:83], v[28:31], v[44:47]
v_mfma_f32_16x16x32_bf16 v[48:51], v[84:87], v[28:31], v[48:51]
s_waitcnt vmcnt(17)
s_barrier
s_add_u32 m0, s56, 73728
s_nop 0
buffer_load_dwordx4 v6, s[40:43], s53 offen offset:0 lds
buffer_load_dwordx4 v7, s[40:43], s53 offen offset:1024 lds
buffer_load_dwordx4 v8, s[40:43], s53 offen offset:2048 lds
s_add_u32 s53, s53, 122880
s_add_u32 m0, s55, 49152
s_nop 0
buffer_load_dwordx4 v2, s[36:39], s52 offen offset:0 lds
buffer_load_dwordx4 v3, s[36:39], s52 offen offset:1024 lds
buffer_load_dwordx4 v4, s[36:39], s52 offen offset:2048 lds
buffer_load_dwordx4 v5, s[36:39], s52 offen offset:3072 lds
s_add_u32 s52, s52, 128
s_add_u32 m0, s56, 0
s_nop 0
buffer_load_dwordx4 v6, s[40:43], s53 offen offset:0 lds
buffer_load_dwordx4 v7, s[40:43], s53 offen offset:1024 lds
buffer_load_dwordx4 v8, s[40:43], s53 offen offset:2048 lds
s_add_u32 s53, s53, 122880
s_mov_b32 s75, 12288
s_cmp_eq_u32 s74, 0
s_cselect_b32 s75, s75, 24576
ds_read_b128 v[88:91], v26 offset:0
ds_read_b128 v[92:95], v26 offset:2048
ds_read_b128 v[96:99], v27 offset:0
ds_read_b128 v[100:103], v27 offset:2048
v_add_u32 v21, s75, v16
v_add_u32 v22, s75, v17
v_add_u32 v23, s75, v18
v_add_u32 v24, s75, v19
v_add_u32 v25, s75, v20
ds_read_b64_tr_b16 v[68:69], v21
ds_read_b64_tr_b16 v[70:71], v21 offset:1536
ds_read_b64_tr_b16 v[72:73], v22
ds_read_b64_tr_b16 v[74:75], v22 offset:1536
ds_read_b64_tr_b16 v[76:77], v23
ds_read_b64_tr_b16 v[78:79], v23 offset:1536
ds_read_b64_tr_b16 v[80:81], v24
ds_read_b64_tr_b16 v[82:83], v24 offset:1536
ds_read_b64_tr_b16 v[84:85], v25
ds_read_b64_tr_b16 v[86:87], v25 offset:1536
s_waitcnt lgkmcnt(10)
v_mfma_f32_16x16x32_bf16 v[52:55], v[28:31], v[88:91], v[52:55]
v_mfma_f32_16x16x32_bf16 v[60:63], v[88:91], v[88:91], v[60:63]
v_mfma_f32_16x16x32_bf16 v[56:59], v[28:31], v[92:95], v[56:59]
v_mfma_f32_16x16x32_bf16 v[64:67], v[92:95], v[92:95], v[64:67]
v_mfma_f32_16x16x32_bf16 v[52:55], v[28:31], v[96:99], v[52:55]
v_mfma_f32_16x16x32_bf16 v[60:63], v[96:99], v[96:99], v[60:63]
v_mfma_f32_16x16x32_bf16 v[56:59], v[28:31], v[100:103], v[56:59]
v_mfma_f32_16x16x32_bf16 v[64:67], v[100:103], v[100:103], v[64:67]
s_waitcnt lgkmcnt(0)
v_mfma_f32_16x16x32_bf16 v[32:35], v[68:71], v[28:31], v[32:35]
v_mfma_f32_16x16x32_bf16 v[36:39], v[72:75], v[28:31], v[36:39]
v_mfma_f32_16x16x32_bf16 v[40:43], v[76:79], v[28:31], v[40:43]
v_mfma_f32_16x16x32_bf16 v[44:47], v[80:83], v[28:31], v[44:47]
v_mfma_f32_16x16x32_bf16 v[48:51], v[84:87], v[28:31], v[48:51]
s_waitcnt vmcnt(17)
s_barrier
s_add_u32 m0, s56, 12288
s_nop 0
buffer_load_dwordx4 v6, s[40:43], s53 offen offset:0 lds
buffer_load_dwordx4 v7, s[40:43], s53 offen offset:1024 lds
buffer_load_dwordx4 v8, s[40:43], s53 offen offset:2048 lds
s_add_u32 s53, s53, 122880
s_add_u32 m0, s55, 0
s_nop 0
buffer_load_dwordx4 v2, s[36:39], s52 offen offset:0 lds
buffer_load_dwordx4 v3, s[36:39], s52 offen offset:1024 lds
buffer_load_dwordx4 v4, s[36:39], s52 offen offset:2048 lds
buffer_load_dwordx4 v5, s[36:39], s52 offen offset:3072 lds
s_add_u32 s52, s52, 128
s_add_u32 m0, s56, 24576
s_nop 0
buffer_load_dwordx4 v6, s[40:43], s53 offen offset:0 lds
buffer_load_dwordx4 v7, s[40:43], s53 offen offset:1024 lds
buffer_load_dwordx4 v8, s[40:43], s53 offen offset:2048 lds
s_add_u32 s53, s53, 122880
s_mov_b32 s75, 36864
s_cmp_eq_u32 s74, 0
s_cselect_b32 s75, s75, 49152
ds_read_b128 v[88:91], v26 offset:16384
ds_read_b128 v[92:95], v26 offset:18432
ds_read_b128 v[96:99], v27 offset:16384
ds_read_b128 v[100:103], v27 offset:18432
v_add_u32 v21, s75, v16
v_add_u32 v22, s75, v17
v_add_u32 v23, s75, v18
v_add_u32 v24, s75, v19
v_add_u32 v25, s75, v20
ds_read_b64_tr_b16 v[68:69], v21
ds_read_b64_tr_b16 v[70:71], v21 offset:1536
ds_read_b64_tr_b16 v[72:73], v22
ds_read_b64_tr_b16 v[74:75], v22 offset:1536
ds_read_b64_tr_b16 v[76:77], v23
ds_read_b64_tr_b16 v[78:79], v23 offset:1536
ds_read_b64_tr_b16 v[80:81], v24
ds_read_b64_tr_b16 v[82:83], v24 offset:1536
ds_read_b64_tr_b16 v[84:85], v25
ds_read_b64_tr_b16 v[86:87], v25 offset:1536
s_waitcnt lgkmcnt(10)
v_mfma_f32_16x16x32_bf16 v[52:55], v[28:31], v[88:91], v[52:55]
v_mfma_f32_16x16x32_bf16 v[60:63], v[88:91], v[88:91], v[60:63]
v_mfma_f32_16x16x32_bf16 v[56:59], v[28:31], v[92:95], v[56:59]
v_mfma_f32_16x16x32_bf16 v[64:67], v[92:95], v[92:95], v[64:67]
v_mfma_f32_16x16x32_bf16 v[52:55], v[28:31], v[96:99], v[52:55]
v_mfma_f32_16x16x32_bf16 v[60:63], v[96:99], v[96:99], v[60:63]
v_mfma_f32_16x16x32_bf16 v[56:59], v[28:31], v[100:103], v[56:59]
v_mfma_f32_16x16x32_bf16 v[64:67], v[100:103], v[100:103], v[64:67]
s_waitcnt lgkmcnt(0)
v_mfma_f32_16x16x32_bf16 v[32:35], v[68:71], v[28:31], v[32:35]
v_mfma_f32_16x16x32_bf16 v[36:39], v[72:75], v[28:31], v[36:39]
v_mfma_f32_16x16x32_bf16 v[40:43], v[76:79], v[28:31], v[40:43]
v_mfma_f32_16x16x32_bf16 v[44:47], v[80:83], v[28:31], v[44:47]
v_mfma_f32_16x16x32_bf16 v[48:51], v[84:87], v[28:31], v[48:51]
s_waitcnt vmcnt(17)
s_barrier
s_add_u32 m0, s56, 36864
s_nop 0
buffer_load_dwordx4 v6, s[40:43], s53 offen offset:0 lds
buffer_load_dwordx4 v7, s[40:43], s53 offen offset:1024 lds
buffer_load_dwordx4 v8, s[40:43], s53 offen offset:2048 lds
s_add_u32 s53, s53, 122880
s_add_u32 m0, s55, 16384
s_nop 0
buffer_load_dwordx4 v2, s[36:39], s52 offen offset:0 lds
buffer_load_dwordx4 v3, s[36:39], s52 offen offset:1024 lds
buffer_load_dwordx4 v4, s[36:39], s52 offen offset:2048 lds
buffer_load_dwordx4 v5, s[36:39], s52 offen offset:3072 lds
s_add_u32 s52, s52, 128
s_add_u32 m0, s56, 49152
s_nop 0
buffer_load_dwordx4 v6, s[40:43], s53 offen offset:0 lds
buffer_load_dwordx4 v7, s[40:43], s53 offen offset:1024 lds
buffer_load_dwordx4 v8, s[40:43], s53 offen offset:2048 lds
s_add_u32 s53, s53, 122880
s_mov_b32 s75, 61440
s_cmp_eq_u32 s74, 0
s_cselect_b32 s75, s75, 73728
ds_read_b128 v[88:91], v26 offset:32768
ds_read_b128 v[92:95], v26 offset:34816
ds_read_b128 v[96:99], v27 offset:32768
ds_read_b128 v[100:103], v27 offset:34816
v_add_u32 v21, s75, v16
v_add_u32 v22, s75, v17
v_add_u32 v23, s75, v18
v_add_u32 v24, s75, v19
v_add_u32 v25, s75, v20
ds_read_b64_tr_b16 v[68:69], v21
ds_read_b64_tr_b16 v[70:71], v21 offset:1536
ds_read_b64_tr_b16 v[72:73], v22
ds_read_b64_tr_b16 v[74:75], v22 offset:1536
ds_read_b64_tr_b16 v[76:77], v23
ds_read_b64_tr_b16 v[78:79], v23 offset:1536
ds_read_b64_tr_b16 v[80:81], v24
ds_read_b64_tr_b16 v[82:83], v24 offset:1536
ds_read_b64_tr_b16 v[84:85], v25
ds_read_b64_tr_b16 v[86:87], v25 offset:1536
s_waitcnt lgkmcnt(10)
v_mfma_f32_16x16x32_bf16 v[52:55], v[28:31], v[88:91], v[52:55]
v_mfma_f32_16x16x32_bf16 v[60:63], v[88:91], v[88:91], v[60:63]
v_mfma_f32_16x16x32_bf16 v[56:59], v[28:31], v[92:95], v[56:59]
v_mfma_f32_16x16x32_bf16 v[64:67], v[92:95], v[92:95], v[64:67]
v_mfma_f32_16x16x32_bf16 v[52:55], v[28:31], v[96:99], v[52:55]
v_mfma_f32_16x16x32_bf16 v[60:63], v[96:99], v[96:99], v[60:63]
v_mfma_f32_16x16x32_bf16 v[56:59], v[28:31], v[100:103], v[56:59]
v_mfma_f32_16x16x32_bf16 v[64:67], v[100:103], v[100:103], v[64:67]
s_waitcnt lgkmcnt(0)
v_mfma_f32_16x16x32_bf16 v[32:35], v[68:71], v[28:31], v[32:35]
v_mfma_f32_16x16x32_bf16 v[36:39], v[72:75], v[28:31], v[36:39]
v_mfma_f32_16x16x32_bf16 v[40:43], v[76:79], v[28:31], v[40:43]
v_mfma_f32_16x16x32_bf16 v[44:47], v[80:83], v[28:31], v[44:47]
v_mfma_f32_16x16x32_bf16 v[48:51], v[84:87], v[28:31], v[48:51]
s_cmp_eq_u32 s59, 0
s_cbranch_scc0 Lpk_1
v_lshrrev_b32 v232, 4, v1
v_and_b32 v233, 3, v1
v_bfe_u32 v234, v1, 2, 2
v_mul_u32_u24 v234, 40, v234
v_mul_u32_u24 v235, 800, v232
v_add_u32 v235, 0, v235
v_cmp_eq_u32 vcc, v232, v233
v_mov_b32 v236, 8192
s_nop 0
v_cndmask_b32 v235, v236, v235, vcc
v_add_u32 v14, v235, v234
s_branch Lpq_2
Lpk_1:
v_lshrrev_b32 v232, 4, v1
v_and_b32 v233, 3, v1
v_bfe_u32 v234, v1, 2, 2
v_mul_u32_u24 v234, 40, v234
v_mul_u32_u24 v235, 800, v232
v_add_u32 v235, 3200, v235
v_cmp_eq_u32 vcc, v232, v233
v_mov_b32 v236, 8192
s_nop 0
v_cndmask_b32 v235, v236, v235, vcc
v_add_u32 v14, v235, v234
Lpq_2:
ds_read_b64_tr_b16 v[120:121], v14 offset:0
ds_read_b64_tr_b16 v[122:123], v14 offset:160
ds_read_b64_tr_b16 v[124:125], v14 offset:320
ds_read_b64_tr_b16 v[126:127], v14 offset:480
ds_read_b64_tr_b16 v[128:129], v14 offset:640
ds_read_b64_tr_b16 v[130:131], v14 offset:8
ds_read_b64_tr_b16 v[132:133], v14 offset:168
ds_read_b64_tr_b16 v[134:135], v14 offset:328
ds_read_b64_tr_b16 v[136:137], v14 offset:488
ds_read_b64_tr_b16 v[138:139], v14 offset:648
ds_read_b64_tr_b16 v[140:141], v14 offset:16
ds_read_b64_tr_b16 v[142:143], v14 offset:176
ds_read_b64_tr_b16 v[144:145], v14 offset:336
ds_read_b64_tr_b16 v[146:147], v14 offset:496
ds_read_b64_tr_b16 v[148:149], v14 offset:656
ds_read_b64_tr_b16 v[150:151], v14 offset:24
ds_read_b64_tr_b16 v[152:153], v14 offset:184
ds_read_b64_tr_b16 v[154:155], v14 offset:344
ds_read_b64_tr_b16 v[156:157], v14 offset:504
ds_read_b64_tr_b16 v[158:159], v14 offset:664
ds_read_b64_tr_b16 v[160:161], v14 offset:32
ds_read_b64_tr_b16 v[162:163], v14 offset:192
ds_read_b64_tr_b16 v[164:165], v14 offset:352
ds_read_b64_tr_b16 v[166:167], v14 offset:512
ds_read_b64_tr_b16 v[168:169], v14 offset:672
s_waitcnt vmcnt(17)
s_barrier
s_add_u32 m0, s56, 61440
s_nop 0
buffer_load_dwordx4 v6, s[40:43], s53 offen offset:0 lds
buffer_load_dwordx4 v7, s[40:43], s53 offen offset:1024 lds
buffer_load_dwordx4 v8, s[40:43], s53 offen offset:2048 lds
s_add_u32 s53, s53, 122880
s_mov_b32 s75, 0
s_cmp_eq_u32 s74, 0
s_cselect_b32 s75, s75, 12288
ds_read_b128 v[88:91], v26 offset:49152
ds_read_b128 v[92:95], v26 offset:51200
ds_read_b128 v[96:99], v27 offset:49152
ds_read_b128 v[100:103], v27 offset:51200
v_add_u32 v21, s75, v16
v_add_u32 v22, s75, v17
v_add_u32 v23, s75, v18
v_add_u32 v24, s75, v19
v_add_u32 v25, s75, v20
ds_read_b64_tr_b16 v[68:69], v21
ds_read_b64_tr_b16 v[70:71], v21 offset:1536
ds_read_b64_tr_b16 v[72:73], v22
ds_read_b64_tr_b16 v[74:75], v22 offset:1536
ds_read_b64_tr_b16 v[76:77], v23
ds_read_b64_tr_b16 v[78:79], v23 offset:1536
ds_read_b64_tr_b16 v[80:81], v24
ds_read_b64_tr_b16 v[82:83], v24 offset:1536
ds_read_b64_tr_b16 v[84:85], v25
ds_read_b64_tr_b16 v[86:87], v25 offset:1536
s_waitcnt lgkmcnt(10)
v_mfma_f32_16x16x32_bf16 v[52:55], v[28:31], v[88:91], v[52:55]
v_mfma_f32_16x16x32_bf16 v[60:63], v[88:91], v[88:91], v[60:63]
v_mfma_f32_16x16x32_bf16 v[56:59], v[28:31], v[92:95], v[56:59]
v_mfma_f32_16x16x32_bf16 v[64:67], v[92:95], v[92:95], v[64:67]
v_mfma_f32_16x16x32_bf16 v[52:55], v[28:31], v[96:99], v[52:55]
v_mfma_f32_16x16x32_bf16 v[60:63], v[96:99], v[96:99], v[60:63]
v_mfma_f32_16x16x32_bf16 v[56:59], v[28:31], v[100:103], v[56:59]
v_mfma_f32_16x16x32_bf16 v[64:67], v[100:103], v[100:103], v[64:67]
s_waitcnt lgkmcnt(0)
v_mfma_f32_16x16x32_bf16 v[32:35], v[68:71], v[28:31], v[32:35]
v_mfma_f32_16x16x32_bf16 v[36:39], v[72:75], v[28:31], v[36:39]
v_mfma_f32_16x16x32_bf16 v[40:43], v[76:79], v[28:31], v[40:43]
v_mfma_f32_16x16x32_bf16 v[44:47], v[80:83], v[28:31], v[44:47]
v_mfma_f32_16x16x32_bf16 v[48:51], v[84:87], v[28:31], v[48:51]
s_waitcnt vmcnt(10)
s_barrier
s_mov_b32 s75, 24576
s_cmp_eq_u32 s74, 0
s_cselect_b32 s75, s75, 36864
ds_read_b128 v[88:91], v26 offset:0
ds_read_b128 v[92:95], v26 offset:2048
ds_read_b128 v[96:99], v27 offset:0
ds_read_b128 v[100:103], v27 offset:2048
v_add_u32 v21, s75, v16
v_add_u32 v22, s75, v17
v_add_u32 v23, s75, v18
v_add_u32 v24, s75, v19
v_add_u32 v25, s75, v20
ds_read_b64_tr_b16 v[68:69], v21
ds_read_b64_tr_b16 v[70:71], v21 offset:1536
ds_read_b64_tr_b16 v[72:73], v22
ds_read_b64_tr_b16 v[74:75], v22 offset:1536
ds_read_b64_tr_b16 v[76:77], v23
ds_read_b64_tr_b16 v[78:79], v23 offset:1536
ds_read_b64_tr_b16 v[80:81], v24
ds_read_b64_tr_b16 v[82:83], v24 offset:1536
ds_read_b64_tr_b16 v[84:85], v25
ds_read_b64_tr_b16 v[86:87], v25 offset:1536
s_waitcnt lgkmcnt(10)
v_mfma_f32_16x16x32_bf16 v[52:55], v[28:31], v[88:91], v[52:55]
v_mfma_f32_16x16x32_bf16 v[60:63], v[88:91], v[88:91], v[60:63]
v_mfma_f32_16x16x32_bf16 v[56:59], v[28:31], v[92:95], v[56:59]
v_mfma_f32_16x16x32_bf16 v[64:67], v[92:95], v[92:95], v[64:67]
v_mfma_f32_16x16x32_bf16 v[52:55], v[28:31], v[96:99], v[52:55]
v_mfma_f32_16x16x32_bf16 v[60:63], v[96:99], v[96:99], v[60:63]
v_mfma_f32_16x16x32_bf16 v[56:59], v[28:31], v[100:103], v[56:59]
v_mfma_f32_16x16x32_bf16 v[64:67], v[100:103], v[100:103], v[64:67]
s_waitcnt lgkmcnt(0)
v_mfma_f32_16x16x32_bf16 v[32:35], v[68:71], v[28:31], v[32:35]
v_mfma_f32_16x16x32_bf16 v[36:39], v[72:75], v[28:31], v[36:39]
v_mfma_f32_16x16x32_bf16 v[40:43], v[76:79], v[28:31], v[40:43]
v_mfma_f32_16x16x32_bf16 v[44:47], v[80:83], v[28:31], v[44:47]
v_mfma_f32_16x16x32_bf16 v[48:51], v[84:87], v[28:31], v[48:51]
s_waitcnt vmcnt(0)
s_barrier
s_mov_b32 s75, 49152
s_cmp_eq_u32 s74, 0
s_cselect_b32 s75, s75, 61440
ds_read_b128 v[88:91], v26 offset:16384
ds_read_b128 v[92:95], v26 offset:18432
ds_read_b128 v[96:99], v27 offset:16384
ds_read_b128 v[100:103], v27 offset:18432
v_add_u32 v21, s75, v16
v_add_u32 v22, s75, v17
v_add_u32 v23, s75, v18
v_add_u32 v24, s75, v19
v_add_u32 v25, s75, v20
ds_read_b64_tr_b16 v[68:69], v21
ds_read_b64_tr_b16 v[70:71], v21 offset:1536
ds_read_b64_tr_b16 v[72:73], v22
ds_read_b64_tr_b16 v[74:75], v22 offset:1536
ds_read_b64_tr_b16 v[76:77], v23
ds_read_b64_tr_b16 v[78:79], v23 offset:1536
ds_read_b64_tr_b16 v[80:81], v24
ds_read_b64_tr_b16 v[82:83], v24 offset:1536
ds_read_b64_tr_b16 v[84:85], v25
ds_read_b64_tr_b16 v[86:87], v25 offset:1536
s_waitcnt lgkmcnt(10)
v_mfma_f32_16x16x32_bf16 v[52:55], v[28:31], v[88:91], v[52:55]
v_mfma_f32_16x16x32_bf16 v[60:63], v[88:91], v[88:91], v[60:63]
v_mfma_f32_16x16x32_bf16 v[56:59], v[28:31], v[92:95], v[56:59]
v_mfma_f32_16x16x32_bf16 v[64:67], v[92:95], v[92:95], v[64:67]
v_mfma_f32_16x16x32_bf16 v[52:55], v[28:31], v[96:99], v[52:55]
v_mfma_f32_16x16x32_bf16 v[60:63], v[96:99], v[96:99], v[60:63]
v_mfma_f32_16x16x32_bf16 v[56:59], v[28:31], v[100:103], v[56:59]
v_mfma_f32_16x16x32_bf16 v[64:67], v[100:103], v[100:103], v[64:67]
s_waitcnt lgkmcnt(0)
v_mfma_f32_16x16x32_bf16 v[32:35], v[68:71], v[28:31], v[32:35]
v_mfma_f32_16x16x32_bf16 v[36:39], v[72:75], v[28:31], v[36:39]
v_mfma_f32_16x16x32_bf16 v[40:43], v[76:79], v[28:31], v[40:43]
v_mfma_f32_16x16x32_bf16 v[44:47], v[80:83], v[28:31], v[44:47]
v_mfma_f32_16x16x32_bf16 v[48:51], v[84:87], v[28:31], v[48:51]
s_nop 7
v_and_b32 v232, 15, v1
v_lshrrev_b32 v233, 4, v1
v_lshlrev_b32 v234, 4, v233
s_mul_i32 s60, s26, 320
v_add_u32 v234, s60, v234
v_cmp_eq_u32 vcc, 0, v232
s_and_saveexec_b64 s[68:69], vcc
ds_write_b128 v234, v[32:35] offset:9216
ds_write_b128 v234, v[36:39] offset:9280
ds_write_b128 v234, v[40:43] offset:9344
ds_write_b128 v234, v[44:47] offset:9408
ds_write_b128 v234, v[48:51] offset:9472
s_mov_b64 exec, s[68:69]
v_and_b32 v234, 3, v1
v_cmp_eq_u32 s[68:69], 1, v234
v_cmp_eq_u32 s[70:71], 2, v234
v_cmp_eq_u32 s[72:73], 3, v234
v_lshrrev_b32 v235, 2, v232
v_lshlrev_b32 v235, 4, v235
v_add_u32 v235, v235, v232
v_lshlrev_b32 v235, 2, v235
v_cndmask_b32 v236, v60, v61, s[68:69]
v_cndmask_b32 v236, v236, v62, s[70:71]
v_cndmask_b32 v236, v236, v63, s[72:73]
v_cndmask_b32 v237, v64, v65, s[68:69]
v_cndmask_b32 v237, v237, v66, s[70:71]
v_cndmask_b32 v237, v237, v67, s[72:73]
ds_bpermute_b32 v238, v235, v236
ds_bpermute_b32 v239, v235, v237
s_mov_b32 s60, 0x3acccccd
s_waitcnt lgkmcnt(0)
v_mul_f32 v236, s60, v52
v_mul_f32 v238, s60, v238
v_fma_f32 v238, -v236, v236, v238
v_max_f32 v238, 0, v238
v_add_f32 v238, 0x3727c5ac, v238
v_rsq_f32 v240, v238
s_nop 0
v_mul_f32 v241, v236, v240
v_sub_f32 v241, 0, v241
v_mul_f32 v237, s60, v56
v_mul_f32 v239, s60, v239
v_fma_f32 v239, -v237, v237, v239
v_max_f32 v239, 0, v239
v_add_f32 v239, 0x3727c5ac, v239
v_rsq_f32 v242, v239
s_nop 0
v_mul_f32 v243, v237, v242
v_sub_f32 v243, 0, v243
v_lshlrev_b32 v232, 3, v232
s_lshl_b32 s60, s26, 8
v_add_u32 v232, s60, v232
s_mov_b64 exec, 0xffff
ds_write_b64 v232, v[240:241] offset:10496
ds_write_b64 v232, v[242:243] offset:10624
s_mov_b64 exec, -1
s_waitcnt lgkmcnt(0)
s_barrier
s_barrier
s_mov_b32 s64, 0x3fb8aa3b
s_mov_b32 s65, 0xbfb8aa3b
s_mov_b32 s70, 0x3fb8aa3b
s_mov_b32 s71, 0x3fb8aa3b
v_lshlrev_b32 v2, 4, v1
s_mul_i32 s60, s26, 10240
s_add_u32 s60, s60, 100352
v_add_u32 v2, s60, v2
s_cmp_eq_u32 s59, 0
s_cbranch_scc0 Lp1_ld_q
ds_read_b128 v[20:23], v2 offset:0
ds_read_b128 v[24:27], v2 offset:1024
ds_read_b128 v[28:31], v2 offset:2048
ds_read_b128 v[32:35], v2 offset:3072
ds_read_b128 v[36:39], v2 offset:4096
v_and_b32 v232, 15, v1
v_lshlrev_b32 v232, 3, v232
s_lshl_b32 s60, s26, 8
v_add_u32 v232, s60, v232
ds_read_b64 v[230:231], v232 offset:10496
ds_read_b64 v[240:241], v232 offset:10624
v_lshrrev_b32 v233, 4, v1
v_lshlrev_b32 v234, 4, v233
ds_read_b128 v[170:173], v234 offset:9216
ds_read_b128 v[190:193], v234 offset:9536
ds_read_b128 v[174:177], v234 offset:9280
ds_read_b128 v[194:197], v234 offset:9600
ds_read_b128 v[178:181], v234 offset:9344
ds_read_b128 v[198:201], v234 offset:9664
ds_read_b128 v[182:185], v234 offset:9408
ds_read_b128 v[202:205], v234 offset:9728
ds_read_b128 v[186:189], v234 offset:9472
ds_read_b128 v[206:209], v234 offset:9792
s_waitcnt lgkmcnt(0)
v_pk_add_f32 v[170:171], v[170:171], v[190:191]
v_pk_add_f32 v[172:173], v[172:173], v[192:193]
v_pk_add_f32 v[174:175], v[174:175], v[194:195]
v_pk_add_f32 v[176:177], v[176:177], v[196:197]
v_pk_add_f32 v[178:179], v[178:179], v[198:199]
v_pk_add_f32 v[180:181], v[180:181], v[200:201]
v_pk_add_f32 v[182:183], v[182:183], v[202:203]
v_pk_add_f32 v[184:185], v[184:185], v[204:205]
v_pk_add_f32 v[186:187], v[186:187], v[206:207]
v_pk_add_f32 v[188:189], v[188:189], v[208:209]
v_pk_mul_f32 v[206:207], v[170:171], v[240:241] op_sel:[0,1] op_sel_hi:[1,1]
v_pk_fma_f32 v[20:21], v[20:21], v[240:241], v[206:207] op_sel_hi:[1,0,1]
v_pk_mul_f32 v[206:207], v[172:173], v[240:241] op_sel:[0,1] op_sel_hi:[1,1]
v_pk_fma_f32 v[22:23], v[22:23], v[240:241], v[206:207] op_sel_hi:[1,0,1]
v_pk_mul_f32 v[206:207], v[174:175], v[240:241] op_sel:[0,1] op_sel_hi:[1,1]
v_pk_fma_f32 v[24:25], v[24:25], v[240:241], v[206:207] op_sel_hi:[1,0,1]
v_pk_mul_f32 v[206:207], v[176:177], v[240:241] op_sel:[0,1] op_sel_hi:[1,1]
v_pk_fma_f32 v[26:27], v[26:27], v[240:241], v[206:207] op_sel_hi:[1,0,1]
v_pk_mul_f32 v[206:207], v[178:179], v[240:241] op_sel:[0,1] op_sel_hi:[1,1]
v_pk_fma_f32 v[28:29], v[28:29], v[240:241], v[206:207] op_sel_hi:[1,0,1]
v_pk_mul_f32 v[206:207], v[180:181], v[240:241] op_sel:[0,1] op_sel_hi:[1,1]
v_pk_fma_f32 v[30:31], v[30:31], v[240:241], v[206:207] op_sel_hi:[1,0,1]
v_pk_mul_f32 v[206:207], v[182:183], v[240:241] op_sel:[0,1] op_sel_hi:[1,1]
v_pk_fma_f32 v[32:33], v[32:33], v[240:241], v[206:207] op_sel_hi:[1,0,1]
v_pk_mul_f32 v[206:207], v[184:185], v[240:241] op_sel:[0,1] op_sel_hi:[1,1]
v_pk_fma_f32 v[34:35], v[34:35], v[240:241], v[206:207] op_sel_hi:[1,0,1]
v_pk_mul_f32 v[206:207], v[186:187], v[240:241] op_sel:[0,1] op_sel_hi:[1,1]
v_pk_fma_f32 v[36:37], v[36:37], v[240:241], v[206:207] op_sel_hi:[1,0,1]
v_pk_mul_f32 v[206:207], v[188:189], v[240:241] op_sel:[0,1] op_sel_hi:[1,1]
v_pk_fma_f32 v[38:39], v[38:39], v[240:241], v[206:207] op_sel_hi:[1,0,1]
v_cvt_pk_bf16_f32 v190, v20, v21
v_cvt_pk_bf16_f32 v191, v22, v23
v_cvt_pk_bf16_f32 v192, v24, v25
v_cvt_pk_bf16_f32 v193, v26, v27
v_cvt_pk_bf16_f32 v194, v28, v29
v_cvt_pk_bf16_f32 v195, v30, v31
v_cvt_pk_bf16_f32 v196, v32, v33
v_cvt_pk_bf16_f32 v197, v34, v35
v_cvt_pk_bf16_f32 v198, v36, v37
v_cvt_pk_bf16_f32 v199, v38, v39
s_nop 1
v_mfma_f32_16x16x32_bf16 v[100:103], v[120:123], v[190:193], 0
v_mfma_f32_16x16x32_bf16 v[104:107], v[130:133], v[190:193], 0
v_mfma_f32_16x16x32_bf16 v[108:111], v[140:143], v[190:193], 0
v_mfma_f32_16x16x32_bf16 v[112:115], v[150:153], v[190:193], 0
v_mfma_f32_16x16x32_bf16 v[116:119], v[160:163], v[190:193], 0
v_mfma_f32_16x16x32_bf16 v[100:103], v[124:127], v[194:197], v[100:103]
v_mfma_f32_16x16x32_bf16 v[104:107], v[134:137], v[194:197], v[104:107]
v_mfma_f32_16x16x32_bf16 v[108:111], v[144:147], v[194:197], v[108:111]
v_mfma_f32_16x16x32_bf16 v[112:115], v[154:157], v[194:197], v[112:115]
v_mfma_f32_16x16x32_bf16 v[116:119], v[164:167], v[194:197], v[116:119]
v_mfma_f32_16x16x16_bf16 v[100:103], v[128:129], v[198:199], v[100:103]
v_mfma_f32_16x16x16_bf16 v[104:107], v[138:139], v[198:199], v[104:107]
v_mfma_f32_16x16x16_bf16 v[108:111], v[148:149], v[198:199], v[108:111]
v_mfma_f32_16x16x16_bf16 v[112:115], v[158:159], v[198:199], v[112:115]
v_mfma_f32_16x16x16_bf16 v[116:119], v[168:169], v[198:199], v[116:119]
s_nop 7
v_max3_f32 v250, v100, v101, v102
v_min3_f32 v252, v100, v101, v102
v_max3_f32 v250, v250, v103, v104
v_min3_f32 v252, v252, v103, v104
v_max3_f32 v250, v250, v105, v106
v_min3_f32 v252, v252, v105, v106
v_max3_f32 v250, v250, v107, v108
v_min3_f32 v252, v252, v107, v108
v_max3_f32 v250, v250, v109, v110
v_min3_f32 v252, v252, v109, v110
v_max3_f32 v250, v250, v111, v112
v_min3_f32 v252, v252, v111, v112
v_max3_f32 v250, v250, v113, v114
v_min3_f32 v252, v252, v113, v114
v_max3_f32 v250, v250, v115, v116
v_min3_f32 v252, v252, v115, v116
v_max3_f32 v250, v250, v117, v118
v_min3_f32 v252, v252, v117, v118
v_max_f32 v250, v250, v119
v_min_f32 v252, v252, v119
v_mul_f32 v250, s65, v250
v_mul_f32 v252, s64, v252
v_pk_fma_f32 v[210:211], v[100:101], s[70:71], v[250:251] op_sel_hi:[1,1,0]
v_pk_fma_f32 v[100:101], v[100:101], s[70:71], v[252:253] op_sel_hi:[1,1,0] neg_lo:[1,0,0] neg_hi:[1,0,0]
v_pk_fma_f32 v[212:213], v[102:103], s[70:71], v[250:251] op_sel_hi:[1,1,0]
v_pk_fma_f32 v[102:103], v[102:103], s[70:71], v[252:253] op_sel_hi:[1,1,0] neg_lo:[1,0,0] neg_hi:[1,0,0]
v_pk_fma_f32 v[214:215], v[104:105], s[70:71], v[250:251] op_sel_hi:[1,1,0]
v_pk_fma_f32 v[104:105], v[104:105], s[70:71], v[252:253] op_sel_hi:[1,1,0] neg_lo:[1,0,0] neg_hi:[1,0,0]
v_pk_fma_f32 v[216:217], v[106:107], s[70:71], v[250:251] op_sel_hi:[1,1,0]
v_pk_fma_f32 v[106:107], v[106:107], s[70:71], v[252:253] op_sel_hi:[1,1,0] neg_lo:[1,0,0] neg_hi:[1,0,0]
v_pk_fma_f32 v[218:219], v[108:109], s[70:71], v[250:251] op_sel_hi:[1,1,0]
v_pk_fma_f32 v[108:109], v[108:109], s[70:71], v[252:253] op_sel_hi:[1,1,0] neg_lo:[1,0,0] neg_hi:[1,0,0]
v_pk_fma_f32 v[220:221], v[110:111], s[70:71], v[250:251] op_sel_hi:[1,1,0]
v_pk_fma_f32 v[110:111], v[110:111], s[70:71], v[252:253] op_sel_hi:[1,1,0] neg_lo:[1,0,0] neg_hi:[1,0,0]
v_pk_fma_f32 v[222:223], v[112:113], s[70:71], v[250:251] op_sel_hi:[1,1,0]
v_pk_fma_f32 v[112:113], v[112:113], s[70:71], v[252:253] op_sel_hi:[1,1,0] neg_lo:[1,0,0] neg_hi:[1,0,0]
v_pk_fma_f32 v[224:225], v[114:115], s[70:71], v[250:251] op_sel_hi:[1,1,0]
v_pk_fma_f32 v[114:115], v[114:115], s[70:71], v[252:253] op_sel_hi:[1,1,0] neg_lo:[1,0,0] neg_hi:[1,0,0]
v_pk_fma_f32 v[226:227], v[116:117], s[70:71], v[250:251] op_sel_hi:[1,1,0]
v_pk_fma_f32 v[116:117], v[116:117], s[70:71], v[252:253] op_sel_hi:[1,1,0] neg_lo:[1,0,0] neg_hi:[1,0,0]
v_pk_fma_f32 v[228:229], v[118:119], s[70:71], v[250:251] op_sel_hi:[1,1,0]
v_pk_fma_f32 v[118:119], v[118:119], s[70:71], v[252:253] op_sel_hi:[1,1,0] neg_lo:[1,0,0] neg_hi:[1,0,0]
v_exp_f32 v210, v210
v_exp_f32 v100, v100
v_exp_f32 v211, v211
v_exp_f32 v101, v101
v_exp_f32 v212, v212
v_exp_f32 v102, v102
v_exp_f32 v213, v213
v_exp_f32 v103, v103
v_exp_f32 v214, v214
v_exp_f32 v104, v104
v_exp_f32 v215, v215
v_exp_f32 v105, v105
v_exp_f32 v216, v216
v_exp_f32 v106, v106
v_exp_f32 v217, v217
v_exp_f32 v107, v107
v_exp_f32 v218, v218
v_exp_f32 v108, v108
v_exp_f32 v219, v219
v_exp_f32 v109, v109
v_exp_f32 v220, v220
v_exp_f32 v110, v110
v_exp_f32 v221, v221
v_exp_f32 v111, v111
v_exp_f32 v222, v222
v_exp_f32 v112, v112
v_exp_f32 v223, v223
v_exp_f32 v113, v113
v_exp_f32 v224, v224
v_exp_f32 v114, v114
v_exp_f32 v225, v225
v_exp_f32 v115, v115
v_exp_f32 v226, v226
v_exp_f32 v116, v116
v_exp_f32 v227, v227
v_exp_f32 v117, v117
v_exp_f32 v228, v228
v_exp_f32 v118, v118
v_exp_f32 v229, v229
v_exp_f32 v119, v119
s_nop 0
v_pk_add_f32 v[250:251], v[210:211], v[212:213]
v_pk_add_f32 v[252:253], v[100:101], v[102:103]
v_pk_add_f32 v[250:251], v[250:251], v[214:215]
v_pk_add_f32 v[252:253], v[252:253], v[104:105]
v_pk_add_f32 v[250:251], v[250:251], v[216:217]
v_pk_add_f32 v[252:253], v[252:253], v[106:107]
v_pk_add_f32 v[250:251], v[250:251], v[218:219]
v_pk_add_f32 v[252:253], v[252:253], v[108:109]
v_pk_add_f32 v[250:251], v[250:251], v[220:221]
v_pk_add_f32 v[252:253], v[252:253], v[110:111]
v_pk_add_f32 v[250:251], v[250:251], v[222:223]
v_pk_add_f32 v[252:253], v[252:253], v[112:113]
v_pk_add_f32 v[250:251], v[250:251], v[224:225]
v_pk_add_f32 v[252:253], v[252:253], v[114:115]
v_pk_add_f32 v[250:251], v[250:251], v[226:227]
v_pk_add_f32 v[252:253], v[252:253], v[116:117]
v_pk_add_f32 v[250:251], v[250:251], v[228:229]
v_pk_add_f32 v[252:253], v[252:253], v[118:119]
v_add_f32 v250, v250, v251
v_add_f32 v252, v252, v253
v_rcp_f32 v250, v250
v_rcp_f32 v252, v252
s_nop 0
v_pk_mul_f32 v[210:211], v[210:211], v[250:251] op_sel_hi:[1,0]
v_pk_mul_f32 v[100:101], v[100:101], v[252:253] op_sel_hi:[1,0]
v_pk_mul_f32 v[212:213], v[212:213], v[250:251] op_sel_hi:[1,0]
v_pk_mul_f32 v[102:103], v[102:103], v[252:253] op_sel_hi:[1,0]
v_pk_mul_f32 v[214:215], v[214:215], v[250:251] op_sel_hi:[1,0]
v_pk_mul_f32 v[104:105], v[104:105], v[252:253] op_sel_hi:[1,0]
v_pk_mul_f32 v[216:217], v[216:217], v[250:251] op_sel_hi:[1,0]
v_pk_mul_f32 v[106:107], v[106:107], v[252:253] op_sel_hi:[1,0]
v_pk_mul_f32 v[218:219], v[218:219], v[250:251] op_sel_hi:[1,0]
v_pk_mul_f32 v[108:109], v[108:109], v[252:253] op_sel_hi:[1,0]
v_pk_mul_f32 v[220:221], v[220:221], v[250:251] op_sel_hi:[1,0]
v_pk_mul_f32 v[110:111], v[110:111], v[252:253] op_sel_hi:[1,0]
v_pk_mul_f32 v[222:223], v[222:223], v[250:251] op_sel_hi:[1,0]
v_pk_mul_f32 v[112:113], v[112:113], v[252:253] op_sel_hi:[1,0]
v_pk_mul_f32 v[224:225], v[224:225], v[250:251] op_sel_hi:[1,0]
v_pk_mul_f32 v[114:115], v[114:115], v[252:253] op_sel_hi:[1,0]
v_pk_mul_f32 v[226:227], v[226:227], v[250:251] op_sel_hi:[1,0]
v_pk_mul_f32 v[116:117], v[116:117], v[252:253] op_sel_hi:[1,0]
v_pk_mul_f32 v[228:229], v[228:229], v[250:251] op_sel_hi:[1,0]
v_pk_mul_f32 v[118:119], v[118:119], v[252:253] op_sel_hi:[1,0]
v_cvt_pk_bf16_f32 v20, v210, v211
v_cvt_pk_bf16_f32 v30, v100, v101
v_cvt_pk_bf16_f32 v21, v212, v213
v_cvt_pk_bf16_f32 v31, v102, v103
v_cvt_pk_bf16_f32 v22, v214, v215
v_cvt_pk_bf16_f32 v32, v104, v105
v_cvt_pk_bf16_f32 v23, v216, v217
v_cvt_pk_bf16_f32 v33, v106, v107
v_cvt_pk_bf16_f32 v24, v218, v219
v_cvt_pk_bf16_f32 v34, v108, v109
v_cvt_pk_bf16_f32 v25, v220, v221
v_cvt_pk_bf16_f32 v35, v110, v111
v_cvt_pk_bf16_f32 v26, v222, v223
v_cvt_pk_bf16_f32 v36, v112, v113
v_cvt_pk_bf16_f32 v27, v224, v225
v_cvt_pk_bf16_f32 v37, v114, v115
v_cvt_pk_bf16_f32 v28, v226, v227
v_cvt_pk_bf16_f32 v38, v116, v117
v_cvt_pk_bf16_f32 v29, v228, v229
v_cvt_pk_bf16_f32 v39, v118, v119
v_and_b32 v232, 15, v1
v_lshrrev_b32 v233, 4, v1
s_lshl_b32 s60, s26, 5
v_add_u32 v232, s60, v232
v_mul_u32_u24 v234, 352, v232
v_mul_u32_u24 v235, 80, v233
v_add_u32 v248, v234, v235
v_mul_u32_u24 v234, 224, v232
v_mul_u32_u24 v235, 48, v233
v_add_u32 v249, v234, v235
v_add_u32 v249, 57344, v249
ds_write_b128 v248, v[20:23] offset:17920
ds_write_b128 v248, v[24:27] offset:17936
ds_write_b128 v248, v[28:31] offset:17952
ds_write_b128 v248, v[32:35] offset:17968
ds_write_b128 v248, v[36:39] offset:17984
s_waitcnt lgkmcnt(0)
s_barrier
s_branch Lp1_exit
Lp1_ld_q:
ds_read_b128 v[20:23], v2 offset:0
ds_read_b128 v[24:27], v2 offset:1024
ds_read_b128 v[28:31], v2 offset:2048
ds_read_b128 v[32:35], v2 offset:3072
ds_read_b128 v[36:39], v2 offset:4096
ds_read_b128 v[40:43], v2 offset:5120
ds_read_b128 v[44:47], v2 offset:6144
ds_read_b128 v[48:51], v2 offset:7168
ds_read_b128 v[52:55], v2 offset:8192
ds_read_b128 v[56:59], v2 offset:9216
v_and_b32 v232, 15, v1
v_lshlrev_b32 v232, 3, v232
s_lshl_b32 s60, s26, 8
v_add_u32 v232, s60, v232
ds_read_b64 v[230:231], v232 offset:10496
ds_read_b64 v[240:241], v232 offset:10624
v_lshrrev_b32 v233, 4, v1
v_lshlrev_b32 v234, 4, v233
ds_read_b128 v[170:173], v234 offset:9856
ds_read_b128 v[190:193], v234 offset:10176
ds_read_b128 v[174:177], v234 offset:9920
ds_read_b128 v[194:197], v234 offset:10240
ds_read_b128 v[178:181], v234 offset:9984
ds_read_b128 v[198:201], v234 offset:10304
ds_read_b128 v[182:185], v234 offset:10048
ds_read_b128 v[202:205], v234 offset:10368
ds_read_b128 v[186:189], v234 offset:10112
ds_read_b128 v[206:209], v234 offset:10432
s_waitcnt lgkmcnt(0)
v_pk_add_f32 v[170:171], v[170:171], v[190:191]
v_pk_add_f32 v[172:173], v[172:173], v[192:193]
v_pk_add_f32 v[174:175], v[174:175], v[194:195]
v_pk_add_f32 v[176:177], v[176:177], v[196:197]
v_pk_add_f32 v[178:179], v[178:179], v[198:199]
v_pk_add_f32 v[180:181], v[180:181], v[200:201]
v_pk_add_f32 v[182:183], v[182:183], v[202:203]
v_pk_add_f32 v[184:185], v[184:185], v[204:205]
v_pk_add_f32 v[186:187], v[186:187], v[206:207]
v_pk_add_f32 v[188:189], v[188:189], v[208:209]
v_and_b32 v232, 15, v1
v_lshrrev_b32 v233, 4, v1
v_mul_u32_u24 v233, 2560, v233
v_lshlrev_b32 v232, 4, v232
v_add_u32 v248, v232, v233
s_lshl_b32 s60, s61, 2
s_add_u32 s60, s60, s26
s_lshl_b32 s60, s60, 5
s_lshl_b32 s68, s62, 3
s_add_u32 s60, s60, s68
s_add_u32 s60, s60, 4
s_mul_i32 s60, s60, 2560
s_add_u32 s69, s60, 131072
v_pk_mul_f32 v[206:207], v[170:171], v[230:231] op_sel:[0,1] op_sel_hi:[1,1]
v_pk_fma_f32 v[20:21], v[20:21], v[230:231], v[206:207] op_sel_hi:[1,0,1]
v_pk_mul_f32 v[206:207], v[172:173], v[230:231] op_sel:[0,1] op_sel_hi:[1,1]
v_pk_fma_f32 v[22:23], v[22:23], v[230:231], v[206:207] op_sel_hi:[1,0,1]
v_pk_mul_f32 v[206:207], v[174:175], v[230:231] op_sel:[0,1] op_sel_hi:[1,1]
v_pk_fma_f32 v[24:25], v[24:25], v[230:231], v[206:207] op_sel_hi:[1,0,1]
v_pk_mul_f32 v[206:207], v[176:177], v[230:231] op_sel:[0,1] op_sel_hi:[1,1]
v_pk_fma_f32 v[26:27], v[26:27], v[230:231], v[206:207] op_sel_hi:[1,0,1]
v_pk_mul_f32 v[206:207], v[178:179], v[230:231] op_sel:[0,1] op_sel_hi:[1,1]
v_pk_fma_f32 v[28:29], v[28:29], v[230:231], v[206:207] op_sel_hi:[1,0,1]
v_pk_mul_f32 v[206:207], v[180:181], v[230:231] op_sel:[0,1] op_sel_hi:[1,1]
v_pk_fma_f32 v[30:31], v[30:31], v[230:231], v[206:207] op_sel_hi:[1,0,1]
v_pk_mul_f32 v[206:207], v[182:183], v[230:231] op_sel:[0,1] op_sel_hi:[1,1]
v_pk_fma_f32 v[32:33], v[32:33], v[230:231], v[206:207] op_sel_hi:[1,0,1]
v_pk_mul_f32 v[206:207], v[184:185], v[230:231] op_sel:[0,1] op_sel_hi:[1,1]
v_pk_fma_f32 v[34:35], v[34:35], v[230:231], v[206:207] op_sel_hi:[1,0,1]
v_pk_mul_f32 v[206:207], v[186:187], v[230:231] op_sel:[0,1] op_sel_hi:[1,1]
v_pk_fma_f32 v[36:37], v[36:37], v[230:231], v[206:207] op_sel_hi:[1,0,1]
v_pk_mul_f32 v[206:207], v[188:189], v[230:231] op_sel:[0,1] op_sel_hi:[1,1]
v_pk_fma_f32 v[38:39], v[38:39], v[230:231], v[206:207] op_sel_hi:[1,0,1]
v_cvt_pk_bf16_f32 v190, v20, v21
v_cvt_pk_bf16_f32 v191, v22, v23
v_cvt_pk_bf16_f32 v192, v24, v25
v_cvt_pk_bf16_f32 v193, v26, v27
v_cvt_pk_bf16_f32 v194, v28, v29
v_cvt_pk_bf16_f32 v195, v30, v31
v_cvt_pk_bf16_f32 v196, v32, v33
v_cvt_pk_bf16_f32 v197, v34, v35
v_cvt_pk_bf16_f32 v198, v36, v37
v_cvt_pk_bf16_f32 v199, v38, v39
s_nop 1
v_mfma_f32_16x16x32_bf16 v[100:103], v[120:123], v[190:193], 0
v_mfma_f32_16x16x32_bf16 v[104:107], v[130:133], v[190:193], 0
v_mfma_f32_16x16x32_bf16 v[108:111], v[140:143], v[190:193], 0
v_mfma_f32_16x16x32_bf16 v[112:115], v[150:153], v[190:193], 0
v_mfma_f32_16x16x32_bf16 v[116:119], v[160:163], v[190:193], 0
v_mfma_f32_16x16x32_bf16 v[100:103], v[124:127], v[194:197], v[100:103]
v_mfma_f32_16x16x32_bf16 v[104:107], v[134:137], v[194:197], v[104:107]
v_mfma_f32_16x16x32_bf16 v[108:111], v[144:147], v[194:197], v[108:111]
v_mfma_f32_16x16x32_bf16 v[112:115], v[154:157], v[194:197], v[112:115]
v_mfma_f32_16x16x32_bf16 v[116:119], v[164:167], v[194:197], v[116:119]
v_mfma_f32_16x16x16_bf16 v[100:103], v[128:129], v[198:199], v[100:103]
v_mfma_f32_16x16x16_bf16 v[104:107], v[138:139], v[198:199], v[104:107]
v_mfma_f32_16x16x16_bf16 v[108:111], v[148:149], v[198:199], v[108:111]
v_mfma_f32_16x16x16_bf16 v[112:115], v[158:159], v[198:199], v[112:115]
v_mfma_f32_16x16x16_bf16 v[116:119], v[168:169], v[198:199], v[116:119]
s_nop 7
v_max3_f32 v250, v100, v101, v102
v_min3_f32 v252, v100, v101, v102
v_max3_f32 v250, v250, v103, v104
v_min3_f32 v252, v252, v103, v104
v_max3_f32 v250, v250, v105, v106
v_min3_f32 v252, v252, v105, v106
v_max3_f32 v250, v250, v107, v108
v_min3_f32 v252, v252, v107, v108
v_max3_f32 v250, v250, v109, v110
v_min3_f32 v252, v252, v109, v110
v_max3_f32 v250, v250, v111, v112
v_min3_f32 v252, v252, v111, v112
v_max3_f32 v250, v250, v113, v114
v_min3_f32 v252, v252, v113, v114
v_max3_f32 v250, v250, v115, v116
v_min3_f32 v252, v252, v115, v116
v_max3_f32 v250, v250, v117, v118
v_min3_f32 v252, v252, v117, v118
v_max_f32 v250, v250, v119
v_min_f32 v252, v252, v119
v_mul_f32 v250, s65, v250
v_mul_f32 v252, s64, v252
v_pk_fma_f32 v[210:211], v[100:101], s[70:71], v[250:251] op_sel_hi:[1,1,0]
v_pk_fma_f32 v[100:101], v[100:101], s[70:71], v[252:253] op_sel_hi:[1,1,0] neg_lo:[1,0,0] neg_hi:[1,0,0]
v_pk_fma_f32 v[212:213], v[102:103], s[70:71], v[250:251] op_sel_hi:[1,1,0]
v_pk_fma_f32 v[102:103], v[102:103], s[70:71], v[252:253] op_sel_hi:[1,1,0] neg_lo:[1,0,0] neg_hi:[1,0,0]
v_pk_fma_f32 v[214:215], v[104:105], s[70:71], v[250:251] op_sel_hi:[1,1,0]
v_pk_fma_f32 v[104:105], v[104:105], s[70:71], v[252:253] op_sel_hi:[1,1,0] neg_lo:[1,0,0] neg_hi:[1,0,0]
v_pk_fma_f32 v[216:217], v[106:107], s[70:71], v[250:251] op_sel_hi:[1,1,0]
v_pk_fma_f32 v[106:107], v[106:107], s[70:71], v[252:253] op_sel_hi:[1,1,0] neg_lo:[1,0,0] neg_hi:[1,0,0]
v_pk_fma_f32 v[218:219], v[108:109], s[70:71], v[250:251] op_sel_hi:[1,1,0]
v_pk_fma_f32 v[108:109], v[108:109], s[70:71], v[252:253] op_sel_hi:[1,1,0] neg_lo:[1,0,0] neg_hi:[1,0,0]
v_pk_fma_f32 v[220:221], v[110:111], s[70:71], v[250:251] op_sel_hi:[1,1,0]
v_pk_fma_f32 v[110:111], v[110:111], s[70:71], v[252:253] op_sel_hi:[1,1,0] neg_lo:[1,0,0] neg_hi:[1,0,0]
v_pk_fma_f32 v[222:223], v[112:113], s[70:71], v[250:251] op_sel_hi:[1,1,0]
v_pk_fma_f32 v[112:113], v[112:113], s[70:71], v[252:253] op_sel_hi:[1,1,0] neg_lo:[1,0,0] neg_hi:[1,0,0]
v_pk_fma_f32 v[224:225], v[114:115], s[70:71], v[250:251] op_sel_hi:[1,1,0]
v_pk_fma_f32 v[114:115], v[114:115], s[70:71], v[252:253] op_sel_hi:[1,1,0] neg_lo:[1,0,0] neg_hi:[1,0,0]
v_pk_fma_f32 v[226:227], v[116:117], s[70:71], v[250:251] op_sel_hi:[1,1,0]
v_pk_fma_f32 v[116:117], v[116:117], s[70:71], v[252:253] op_sel_hi:[1,1,0] neg_lo:[1,0,0] neg_hi:[1,0,0]
v_pk_fma_f32 v[228:229], v[118:119], s[70:71], v[250:251] op_sel_hi:[1,1,0]
v_pk_fma_f32 v[118:119], v[118:119], s[70:71], v[252:253] op_sel_hi:[1,1,0] neg_lo:[1,0,0] neg_hi:[1,0,0]
v_exp_f32 v210, v210
v_exp_f32 v100, v100
v_exp_f32 v211, v211
v_exp_f32 v101, v101
v_exp_f32 v212, v212
v_exp_f32 v102, v102
v_exp_f32 v213, v213
v_exp_f32 v103, v103
v_exp_f32 v214, v214
v_exp_f32 v104, v104
v_exp_f32 v215, v215
v_exp_f32 v105, v105
v_exp_f32 v216, v216
v_exp_f32 v106, v106
v_exp_f32 v217, v217
v_exp_f32 v107, v107
v_exp_f32 v218, v218
v_exp_f32 v108, v108
v_exp_f32 v219, v219
v_exp_f32 v109, v109
v_exp_f32 v220, v220
v_exp_f32 v110, v110
v_exp_f32 v221, v221
v_exp_f32 v111, v111
v_exp_f32 v222, v222
v_exp_f32 v112, v112
v_exp_f32 v223, v223
v_exp_f32 v113, v113
v_exp_f32 v224, v224
v_exp_f32 v114, v114
v_exp_f32 v225, v225
v_exp_f32 v115, v115
v_exp_f32 v226, v226
v_exp_f32 v116, v116
v_exp_f32 v227, v227
v_exp_f32 v117, v117
v_exp_f32 v228, v228
v_exp_f32 v118, v118
v_exp_f32 v229, v229
v_exp_f32 v119, v119
s_nop 0
v_pk_add_f32 v[250:251], v[210:211], v[212:213]
v_pk_add_f32 v[252:253], v[100:101], v[102:103]
v_pk_add_f32 v[250:251], v[250:251], v[214:215]
v_pk_add_f32 v[252:253], v[252:253], v[104:105]
v_pk_add_f32 v[250:251], v[250:251], v[216:217]
v_pk_add_f32 v[252:253], v[252:253], v[106:107]
v_pk_add_f32 v[250:251], v[250:251], v[218:219]
v_pk_add_f32 v[252:253], v[252:253], v[108:109]
v_pk_add_f32 v[250:251], v[250:251], v[220:221]
v_pk_add_f32 v[252:253], v[252:253], v[110:111]
v_pk_add_f32 v[250:251], v[250:251], v[222:223]
v_pk_add_f32 v[252:253], v[252:253], v[112:113]
v_pk_add_f32 v[250:251], v[250:251], v[224:225]
v_pk_add_f32 v[252:253], v[252:253], v[114:115]
v_pk_add_f32 v[250:251], v[250:251], v[226:227]
v_pk_add_f32 v[252:253], v[252:253], v[116:117]
v_pk_add_f32 v[250:251], v[250:251], v[228:229]
v_pk_add_f32 v[252:253], v[252:253], v[118:119]
v_add_f32 v250, v250, v251
v_add_f32 v252, v252, v253
v_rcp_f32 v250, v250
v_rcp_f32 v252, v252
s_nop 0
v_pk_mul_f32 v[210:211], v[210:211], v[250:251] op_sel_hi:[1,0]
v_pk_mul_f32 v[100:101], v[100:101], v[252:253] op_sel_hi:[1,0]
v_pk_mul_f32 v[212:213], v[212:213], v[250:251] op_sel_hi:[1,0]
v_pk_mul_f32 v[102:103], v[102:103], v[252:253] op_sel_hi:[1,0]
v_pk_mul_f32 v[214:215], v[214:215], v[250:251] op_sel_hi:[1,0]
v_pk_mul_f32 v[104:105], v[104:105], v[252:253] op_sel_hi:[1,0]
v_pk_mul_f32 v[216:217], v[216:217], v[250:251] op_sel_hi:[1,0]
v_pk_mul_f32 v[106:107], v[106:107], v[252:253] op_sel_hi:[1,0]
v_pk_mul_f32 v[218:219], v[218:219], v[250:251] op_sel_hi:[1,0]
v_pk_mul_f32 v[108:109], v[108:109], v[252:253] op_sel_hi:[1,0]
v_pk_mul_f32 v[220:221], v[220:221], v[250:251] op_sel_hi:[1,0]
v_pk_mul_f32 v[110:111], v[110:111], v[252:253] op_sel_hi:[1,0]
v_pk_mul_f32 v[222:223], v[222:223], v[250:251] op_sel_hi:[1,0]
v_pk_mul_f32 v[112:113], v[112:113], v[252:253] op_sel_hi:[1,0]
v_pk_mul_f32 v[224:225], v[224:225], v[250:251] op_sel_hi:[1,0]
v_pk_mul_f32 v[114:115], v[114:115], v[252:253] op_sel_hi:[1,0]
v_pk_mul_f32 v[226:227], v[226:227], v[250:251] op_sel_hi:[1,0]
v_pk_mul_f32 v[116:117], v[116:117], v[252:253] op_sel_hi:[1,0]
v_pk_mul_f32 v[228:229], v[228:229], v[250:251] op_sel_hi:[1,0]
v_pk_mul_f32 v[118:119], v[118:119], v[252:253] op_sel_hi:[1,0]
v_cvt_pk_bf16_f32 v20, v210, v211
v_cvt_pk_bf16_f32 v30, v100, v101
v_cvt_pk_bf16_f32 v21, v212, v213
v_cvt_pk_bf16_f32 v31, v102, v103
v_cvt_pk_bf16_f32 v22, v214, v215
v_cvt_pk_bf16_f32 v32, v104, v105
v_cvt_pk_bf16_f32 v23, v216, v217
v_cvt_pk_bf16_f32 v33, v106, v107
v_cvt_pk_bf16_f32 v24, v218, v219
v_cvt_pk_bf16_f32 v34, v108, v109
v_cvt_pk_bf16_f32 v25, v220, v221
v_cvt_pk_bf16_f32 v35, v110, v111
v_cvt_pk_bf16_f32 v26, v222, v223
v_cvt_pk_bf16_f32 v36, v112, v113
v_cvt_pk_bf16_f32 v27, v224, v225
v_cvt_pk_bf16_f32 v37, v114, v115
v_cvt_pk_bf16_f32 v28, v226, v227
v_cvt_pk_bf16_f32 v38, v116, v117
v_cvt_pk_bf16_f32 v29, v228, v229
v_cvt_pk_bf16_f32 v39, v118, v119
buffer_store_dwordx4 v[20:23], v248, s[32:35], s69 offen offset:0 sc0 sc1
buffer_store_dwordx4 v[24:27], v248, s[32:35], s69 offen offset:512 sc0 sc1
buffer_store_dwordx4 v[28:31], v248, s[32:35], s69 offen offset:1024 sc0 sc1
buffer_store_dwordx4 v[32:35], v248, s[32:35], s69 offen offset:1536 sc0 sc1
buffer_store_dwordx4 v[36:39], v248, s[32:35], s69 offen offset:2048 sc0 sc1
v_pk_mul_f32 v[206:207], v[170:171], v[240:241] op_sel:[0,1] op_sel_hi:[1,1]
v_pk_fma_f32 v[40:41], v[40:41], v[240:241], v[206:207] op_sel_hi:[1,0,1]
v_pk_mul_f32 v[206:207], v[172:173], v[240:241] op_sel:[0,1] op_sel_hi:[1,1]
v_pk_fma_f32 v[42:43], v[42:43], v[240:241], v[206:207] op_sel_hi:[1,0,1]
v_pk_mul_f32 v[206:207], v[174:175], v[240:241] op_sel:[0,1] op_sel_hi:[1,1]
v_pk_fma_f32 v[44:45], v[44:45], v[240:241], v[206:207] op_sel_hi:[1,0,1]
v_pk_mul_f32 v[206:207], v[176:177], v[240:241] op_sel:[0,1] op_sel_hi:[1,1]
v_pk_fma_f32 v[46:47], v[46:47], v[240:241], v[206:207] op_sel_hi:[1,0,1]
v_pk_mul_f32 v[206:207], v[178:179], v[240:241] op_sel:[0,1] op_sel_hi:[1,1]
v_pk_fma_f32 v[48:49], v[48:49], v[240:241], v[206:207] op_sel_hi:[1,0,1]
v_pk_mul_f32 v[206:207], v[180:181], v[240:241] op_sel:[0,1] op_sel_hi:[1,1]
v_pk_fma_f32 v[50:51], v[50:51], v[240:241], v[206:207] op_sel_hi:[1,0,1]
v_pk_mul_f32 v[206:207], v[182:183], v[240:241] op_sel:[0,1] op_sel_hi:[1,1]
v_pk_fma_f32 v[52:53], v[52:53], v[240:241], v[206:207] op_sel_hi:[1,0,1]
v_pk_mul_f32 v[206:207], v[184:185], v[240:241] op_sel:[0,1] op_sel_hi:[1,1]
v_pk_fma_f32 v[54:55], v[54:55], v[240:241], v[206:207] op_sel_hi:[1,0,1]
v_pk_mul_f32 v[206:207], v[186:187], v[240:241] op_sel:[0,1] op_sel_hi:[1,1]
v_pk_fma_f32 v[56:57], v[56:57], v[240:241], v[206:207] op_sel_hi:[1,0,1]
v_pk_mul_f32 v[206:207], v[188:189], v[240:241] op_sel:[0,1] op_sel_hi:[1,1]
v_pk_fma_f32 v[58:59], v[58:59], v[240:241], v[206:207] op_sel_hi:[1,0,1]
v_cvt_pk_bf16_f32 v190, v40, v41
v_cvt_pk_bf16_f32 v191, v42, v43
v_cvt_pk_bf16_f32 v192, v44, v45
v_cvt_pk_bf16_f32 v193, v46, v47
v_cvt_pk_bf16_f32 v194, v48, v49
v_cvt_pk_bf16_f32 v195, v50, v51
v_cvt_pk_bf16_f32 v196, v52, v53
v_cvt_pk_bf16_f32 v197, v54, v55
v_cvt_pk_bf16_f32 v198, v56, v57
v_cvt_pk_bf16_f32 v199, v58, v59
s_nop 1
v_mfma_f32_16x16x32_bf16 v[100:103], v[120:123], v[190:193], 0
v_mfma_f32_16x16x32_bf16 v[104:107], v[130:133], v[190:193], 0
v_mfma_f32_16x16x32_bf16 v[108:111], v[140:143], v[190:193], 0
v_mfma_f32_16x16x32_bf16 v[112:115], v[150:153], v[190:193], 0
v_mfma_f32_16x16x32_bf16 v[116:119], v[160:163], v[190:193], 0
v_mfma_f32_16x16x32_bf16 v[100:103], v[124:127], v[194:197], v[100:103]
v_mfma_f32_16x16x32_bf16 v[104:107], v[134:137], v[194:197], v[104:107]
v_mfma_f32_16x16x32_bf16 v[108:111], v[144:147], v[194:197], v[108:111]
v_mfma_f32_16x16x32_bf16 v[112:115], v[154:157], v[194:197], v[112:115]
v_mfma_f32_16x16x32_bf16 v[116:119], v[164:167], v[194:197], v[116:119]
v_mfma_f32_16x16x16_bf16 v[100:103], v[128:129], v[198:199], v[100:103]
v_mfma_f32_16x16x16_bf16 v[104:107], v[138:139], v[198:199], v[104:107]
v_mfma_f32_16x16x16_bf16 v[108:111], v[148:149], v[198:199], v[108:111]
v_mfma_f32_16x16x16_bf16 v[112:115], v[158:159], v[198:199], v[112:115]
v_mfma_f32_16x16x16_bf16 v[116:119], v[168:169], v[198:199], v[116:119]
s_nop 7
v_max3_f32 v250, v100, v101, v102
v_min3_f32 v252, v100, v101, v102
v_max3_f32 v250, v250, v103, v104
v_min3_f32 v252, v252, v103, v104
v_max3_f32 v250, v250, v105, v106
v_min3_f32 v252, v252, v105, v106
v_max3_f32 v250, v250, v107, v108
v_min3_f32 v252, v252, v107, v108
v_max3_f32 v250, v250, v109, v110
v_min3_f32 v252, v252, v109, v110
v_max3_f32 v250, v250, v111, v112
v_min3_f32 v252, v252, v111, v112
v_max3_f32 v250, v250, v113, v114
v_min3_f32 v252, v252, v113, v114
v_max3_f32 v250, v250, v115, v116
v_min3_f32 v252, v252, v115, v116
v_max3_f32 v250, v250, v117, v118
v_min3_f32 v252, v252, v117, v118
v_max_f32 v250, v250, v119
v_min_f32 v252, v252, v119
v_mul_f32 v250, s65, v250
v_mul_f32 v252, s64, v252
v_pk_fma_f32 v[210:211], v[100:101], s[70:71], v[250:251] op_sel_hi:[1,1,0]
v_pk_fma_f32 v[100:101], v[100:101], s[70:71], v[252:253] op_sel_hi:[1,1,0] neg_lo:[1,0,0] neg_hi:[1,0,0]
v_pk_fma_f32 v[212:213], v[102:103], s[70:71], v[250:251] op_sel_hi:[1,1,0]
v_pk_fma_f32 v[102:103], v[102:103], s[70:71], v[252:253] op_sel_hi:[1,1,0] neg_lo:[1,0,0] neg_hi:[1,0,0]
v_pk_fma_f32 v[214:215], v[104:105], s[70:71], v[250:251] op_sel_hi:[1,1,0]
v_pk_fma_f32 v[104:105], v[104:105], s[70:71], v[252:253] op_sel_hi:[1,1,0] neg_lo:[1,0,0] neg_hi:[1,0,0]
v_pk_fma_f32 v[216:217], v[106:107], s[70:71], v[250:251] op_sel_hi:[1,1,0]
v_pk_fma_f32 v[106:107], v[106:107], s[70:71], v[252:253] op_sel_hi:[1,1,0] neg_lo:[1,0,0] neg_hi:[1,0,0]
v_pk_fma_f32 v[218:219], v[108:109], s[70:71], v[250:251] op_sel_hi:[1,1,0]
v_pk_fma_f32 v[108:109], v[108:109], s[70:71], v[252:253] op_sel_hi:[1,1,0] neg_lo:[1,0,0] neg_hi:[1,0,0]
v_pk_fma_f32 v[220:221], v[110:111], s[70:71], v[250:251] op_sel_hi:[1,1,0]
v_pk_fma_f32 v[110:111], v[110:111], s[70:71], v[252:253] op_sel_hi:[1,1,0] neg_lo:[1,0,0] neg_hi:[1,0,0]
v_pk_fma_f32 v[222:223], v[112:113], s[70:71], v[250:251] op_sel_hi:[1,1,0]
v_pk_fma_f32 v[112:113], v[112:113], s[70:71], v[252:253] op_sel_hi:[1,1,0] neg_lo:[1,0,0] neg_hi:[1,0,0]
v_pk_fma_f32 v[224:225], v[114:115], s[70:71], v[250:251] op_sel_hi:[1,1,0]
v_pk_fma_f32 v[114:115], v[114:115], s[70:71], v[252:253] op_sel_hi:[1,1,0] neg_lo:[1,0,0] neg_hi:[1,0,0]
v_pk_fma_f32 v[226:227], v[116:117], s[70:71], v[250:251] op_sel_hi:[1,1,0]
v_pk_fma_f32 v[116:117], v[116:117], s[70:71], v[252:253] op_sel_hi:[1,1,0] neg_lo:[1,0,0] neg_hi:[1,0,0]
v_pk_fma_f32 v[228:229], v[118:119], s[70:71], v[250:251] op_sel_hi:[1,1,0]
v_pk_fma_f32 v[118:119], v[118:119], s[70:71], v[252:253] op_sel_hi:[1,1,0] neg_lo:[1,0,0] neg_hi:[1,0,0]
v_exp_f32 v210, v210
v_exp_f32 v100, v100
v_exp_f32 v211, v211
v_exp_f32 v101, v101
v_exp_f32 v212, v212
v_exp_f32 v102, v102
v_exp_f32 v213, v213
v_exp_f32 v103, v103
v_exp_f32 v214, v214
v_exp_f32 v104, v104
v_exp_f32 v215, v215
v_exp_f32 v105, v105
v_exp_f32 v216, v216
v_exp_f32 v106, v106
v_exp_f32 v217, v217
v_exp_f32 v107, v107
v_exp_f32 v218, v218
v_exp_f32 v108, v108
v_exp_f32 v219, v219
v_exp_f32 v109, v109
v_exp_f32 v220, v220
v_exp_f32 v110, v110
v_exp_f32 v221, v221
v_exp_f32 v111, v111
v_exp_f32 v222, v222
v_exp_f32 v112, v112
v_exp_f32 v223, v223
v_exp_f32 v113, v113
v_exp_f32 v224, v224
v_exp_f32 v114, v114
v_exp_f32 v225, v225
v_exp_f32 v115, v115
v_exp_f32 v226, v226
v_exp_f32 v116, v116
v_exp_f32 v227, v227
v_exp_f32 v117, v117
v_exp_f32 v228, v228
v_exp_f32 v118, v118
v_exp_f32 v229, v229
v_exp_f32 v119, v119
s_nop 0
v_pk_add_f32 v[250:251], v[210:211], v[212:213]
v_pk_add_f32 v[252:253], v[100:101], v[102:103]
v_pk_add_f32 v[250:251], v[250:251], v[214:215]
v_pk_add_f32 v[252:253], v[252:253], v[104:105]
v_pk_add_f32 v[250:251], v[250:251], v[216:217]
v_pk_add_f32 v[252:253], v[252:253], v[106:107]
v_pk_add_f32 v[250:251], v[250:251], v[218:219]
v_pk_add_f32 v[252:253], v[252:253], v[108:109]
v_pk_add_f32 v[250:251], v[250:251], v[220:221]
v_pk_add_f32 v[252:253], v[252:253], v[110:111]
v_pk_add_f32 v[250:251], v[250:251], v[222:223]
v_pk_add_f32 v[252:253], v[252:253], v[112:113]
v_pk_add_f32 v[250:251], v[250:251], v[224:225]
v_pk_add_f32 v[252:253], v[252:253], v[114:115]
v_pk_add_f32 v[250:251], v[250:251], v[226:227]
v_pk_add_f32 v[252:253], v[252:253], v[116:117]
v_pk_add_f32 v[250:251], v[250:251], v[228:229]
v_pk_add_f32 v[252:253], v[252:253], v[118:119]
v_add_f32 v250, v250, v251
v_add_f32 v252, v252, v253
v_rcp_f32 v250, v250
v_rcp_f32 v252, v252
s_nop 0
v_pk_mul_f32 v[210:211], v[210:211], v[250:251] op_sel_hi:[1,0]
v_pk_mul_f32 v[100:101], v[100:101], v[252:253] op_sel_hi:[1,0]
v_pk_mul_f32 v[212:213], v[212:213], v[250:251] op_sel_hi:[1,0]
v_pk_mul_f32 v[102:103], v[102:103], v[252:253] op_sel_hi:[1,0]
v_pk_mul_f32 v[214:215], v[214:215], v[250:251] op_sel_hi:[1,0]
v_pk_mul_f32 v[104:105], v[104:105], v[252:253] op_sel_hi:[1,0]
v_pk_mul_f32 v[216:217], v[216:217], v[250:251] op_sel_hi:[1,0]
v_pk_mul_f32 v[106:107], v[106:107], v[252:253] op_sel_hi:[1,0]
v_pk_mul_f32 v[218:219], v[218:219], v[250:251] op_sel_hi:[1,0]
v_pk_mul_f32 v[108:109], v[108:109], v[252:253] op_sel_hi:[1,0]
v_pk_mul_f32 v[220:221], v[220:221], v[250:251] op_sel_hi:[1,0]
v_pk_mul_f32 v[110:111], v[110:111], v[252:253] op_sel_hi:[1,0]
v_pk_mul_f32 v[222:223], v[222:223], v[250:251] op_sel_hi:[1,0]
v_pk_mul_f32 v[112:113], v[112:113], v[252:253] op_sel_hi:[1,0]
v_pk_mul_f32 v[224:225], v[224:225], v[250:251] op_sel_hi:[1,0]
v_pk_mul_f32 v[114:115], v[114:115], v[252:253] op_sel_hi:[1,0]
v_pk_mul_f32 v[226:227], v[226:227], v[250:251] op_sel_hi:[1,0]
v_pk_mul_f32 v[116:117], v[116:117], v[252:253] op_sel_hi:[1,0]
v_pk_mul_f32 v[228:229], v[228:229], v[250:251] op_sel_hi:[1,0]
v_pk_mul_f32 v[118:119], v[118:119], v[252:253] op_sel_hi:[1,0]
v_cvt_pk_bf16_f32 v40, v210, v211
v_cvt_pk_bf16_f32 v50, v100, v101
v_cvt_pk_bf16_f32 v41, v212, v213
v_cvt_pk_bf16_f32 v51, v102, v103
v_cvt_pk_bf16_f32 v42, v214, v215
v_cvt_pk_bf16_f32 v52, v104, v105
v_cvt_pk_bf16_f32 v43, v216, v217
v_cvt_pk_bf16_f32 v53, v106, v107
v_cvt_pk_bf16_f32 v44, v218, v219
v_cvt_pk_bf16_f32 v54, v108, v109
v_cvt_pk_bf16_f32 v45, v220, v221
v_cvt_pk_bf16_f32 v55, v110, v111
v_cvt_pk_bf16_f32 v46, v222, v223
v_cvt_pk_bf16_f32 v56, v112, v113
v_cvt_pk_bf16_f32 v47, v224, v225
v_cvt_pk_bf16_f32 v57, v114, v115
v_cvt_pk_bf16_f32 v48, v226, v227
v_cvt_pk_bf16_f32 v58, v116, v117
v_cvt_pk_bf16_f32 v49, v228, v229
v_cvt_pk_bf16_f32 v59, v118, v119
buffer_store_dwordx4 v[40:43], v248, s[32:35], s69 offen offset:256 sc0 sc1
buffer_store_dwordx4 v[44:47], v248, s[32:35], s69 offen offset:768 sc0 sc1
buffer_store_dwordx4 v[48:51], v248, s[32:35], s69 offen offset:1280 sc0 sc1
buffer_store_dwordx4 v[52:55], v248, s[32:35], s69 offen offset:1792 sc0 sc1
buffer_store_dwordx4 v[56:59], v248, s[32:35], s69 offen offset:2304 sc0 sc1
s_branch Lp1_exit
Lp1_cons:
s_mov_b32 s48, s22
s_mov_b32 s49, s23
s_mov_b32 s50, 0x100
s_mov_b32 s51, 0x00020000
v_and_b32 v1, 63, v0
s_mov_b32 s63, 0
s_cmp_lg_u32 s59, 0
s_cbranch_scc1 Lnoticket_3
s_cmp_lg_u32 s26, 0
s_cbranch_scc1 Lnoticket_3
s_lshl_b32 s60, s62, 2
v_mov_b32 v14, s60
v_mov_b32 v15, 1
s_mov_b64 exec, 1
buffer_atomic_add v15, v14, s[48:51], 0 offen sc0
s_mov_b64 exec, -1
Lnoticket_3:
v_and_b32 v232, 15, v1
v_lshrrev_b32 v233, 4, v1
v_and_b32 v234, 7, v232
v_xor_b32 v234, v234, v233
v_lshlrev_b32 v234, 4, v234
v_lshlrev_b32 v235, 7, v232
v_add_u32 v234, v234, v235
s_lshl_b32 s60, s26, 12
s_add_u32 s60, s60, 12288
v_add_u32 v12, s60, v234
v_xor_b32 v13, 64, v12
s_mul_i32 s68, s62, 160
s_add_u32 s69, s68, 2560
s_add_u32 s68, s68, 1280
s_mul_i32 s70, s62, 320
s_add_u32 s71, s70, 160
s_cmp_eq_u32 s59, 0
s_cselect_b32 s68, s68, s70
s_cselect_b32 s69, s69, s71
s_and_b32 s66, s68, 63
s_and_b32 s67, s69, 63
s_sub_u32 s68, s68, s66
s_sub_u32 s69, s69, s67
v_bfe_u32 v234, v1, 2, 2
v_and_b32 v235, 1, v233
v_lshlrev_b32 v236, 2, v235
v_add_u32 v234, v234, v236
v_lshrrev_b32 v236, 1, v233
v_lshlrev_b32 v236, 4, v236
v_add_u32 v234, v234, v236
v_mul_u32_u24 v234, 192, v234
v_add_u32 v234, 77824, v234
v_lshlrev_b32 v235, 5, v235
v_and_b32 v236, 3, v1
v_mul_u32_u24 v236, 40, v236
v_add_u32 v237, s66, v236
v_add_u32 v238, 0, v237
v_xor_b32 v238, v238, v235
v_add_u32 v2, v238, v234
v_add_u32 v238, 8, v237
v_xor_b32 v238, v238, v235
v_add_u32 v3, v238, v234
v_add_u32 v238, 16, v237
v_xor_b32 v238, v238, v235
v_add_u32 v4, v238, v234
v_add_u32 v238, 24, v237
v_xor_b32 v238, v238, v235
v_add_u32 v5, v238, v234
v_add_u32 v238, 32, v237
v_xor_b32 v238, v238, v235
v_add_u32 v6, v238, v234
v_add_u32 v237, s67, v236
v_add_u32 v238, 0, v237
v_xor_b32 v238, v238, v235
v_add_u32 v7, v238, v234
v_add_u32 v238, 8, v237
v_xor_b32 v238, v238, v235
v_add_u32 v8, v238, v234
v_add_u32 v238, 16, v237
v_xor_b32 v238, v238, v235
v_add_u32 v9, v238, v234
v_add_u32 v238, 24, v237
v_xor_b32 v238, v238, v235
v_add_u32 v10, v238, v234
v_add_u32 v238, 32, v237
v_xor_b32 v238, v238, v235
v_add_u32 v11, v238, v234
v_mov_b32 v20, 0
v_mov_b32 v21, 0
v_mov_b32 v22, 0
v_mov_b32 v23, 0
v_mov_b32 v24, 0
v_mov_b32 v25, 0
v_mov_b32 v26, 0
v_mov_b32 v27, 0
v_mov_b32 v28, 0
v_mov_b32 v29, 0
v_mov_b32 v30, 0
v_mov_b32 v31, 0
v_mov_b32 v32, 0
v_mov_b32 v33, 0
v_mov_b32 v34, 0
v_mov_b32 v35, 0
v_mov_b32 v36, 0
v_mov_b32 v37, 0
v_mov_b32 v38, 0
v_mov_b32 v39, 0
v_mov_b32 v40, 0
v_mov_b32 v41, 0
v_mov_b32 v42, 0
v_mov_b32 v43, 0
v_mov_b32 v44, 0
v_mov_b32 v45, 0
v_mov_b32 v46, 0
v_mov_b32 v47, 0
v_mov_b32 v48, 0
v_mov_b32 v49, 0
v_mov_b32 v50, 0
v_mov_b32 v51, 0
v_mov_b32 v52, 0
v_mov_b32 v53, 0
v_mov_b32 v54, 0
v_mov_b32 v55, 0
v_mov_b32 v56, 0
v_mov_b32 v57, 0
v_mov_b32 v58, 0
v_mov_b32 v59, 0
v_mov_b32 v60, 0
v_mov_b32 v61, 0
v_mov_b32 v62, 0
v_mov_b32 v63, 0
v_mov_b32 v64, 0
v_mov_b32 v65, 0
v_mov_b32 v66, 0
v_mov_b32 v67, 0
v_mov_b32 v68, 0
v_mov_b32 v69, 0
v_mov_b32 v70, 0
v_mov_b32 v71, 0
v_mov_b32 v72, 0
v_mov_b32 v73, 0
v_mov_b32 v74, 0
v_mov_b32 v75, 0
v_mov_b32 v76, 0
v_mov_b32 v77, 0
v_mov_b32 v78, 0
v_mov_b32 v79, 0
v_mov_b32 v80, 0
v_mov_b32 v81, 0
v_mov_b32 v82, 0
v_mov_b32 v83, 0
v_mov_b32 v84, 0
v_mov_b32 v85, 0
v_mov_b32 v86, 0
v_mov_b32 v87, 0
v_mov_b32 v88, 0
v_mov_b32 v89, 0
v_mov_b32 v90, 0
v_mov_b32 v91, 0
v_mov_b32 v92, 0
v_mov_b32 v93, 0
v_mov_b32 v94, 0
v_mov_b32 v95, 0
v_mov_b32 v96, 0
v_mov_b32 v97, 0
v_mov_b32 v98, 0
v_mov_b32 v99, 0
v_lshlrev_b32 v232, 2, v0
v_mov_b32 v233, 0
ds_write_b32 v232, v233 offset:8192
s_mov_b32 s57, 0
s_mov_b32 s54, 0
s_mov_b32 s55, 0
s_mov_b32 s76, 12288
s_mov_b32 s77, 4294893568
s_mov_b32 s78, 16384
s_mov_b32 s79, 4294918144
s_waitcnt lgkmcnt(0)
s_barrier
ds_read_b128 v[200:203], v12 offset:0
ds_read_b128 v[204:207], v12 offset:2048
ds_read_b64_tr_b16 v[120:121], v2 offset:0
ds_read_b64_tr_b16 v[122:123], v2 offset:1536
ds_read_b64_tr_b16 v[124:125], v3 offset:0
ds_read_b64_tr_b16 v[126:127], v3 offset:1536
ds_read_b64_tr_b16 v[128:129], v4 offset:0
ds_read_b64_tr_b16 v[130:131], v4 offset:1536
ds_read_b64_tr_b16 v[132:133], v5 offset:0
ds_read_b64_tr_b16 v[134:135], v5 offset:1536
ds_read_b64_tr_b16 v[136:137], v6 offset:0
ds_read_b64_tr_b16 v[138:139], v6 offset:1536
ds_read_b64_tr_b16 v[140:141], v7 offset:6144
ds_read_b64_tr_b16 v[142:143], v7 offset:7680
ds_read_b64_tr_b16 v[144:145], v8 offset:6144
ds_read_b64_tr_b16 v[146:147], v8 offset:7680
ds_read_b64_tr_b16 v[148:149], v9 offset:6144
ds_read_b64_tr_b16 v[150:151], v9 offset:7680
ds_read_b64_tr_b16 v[152:153], v10 offset:6144
ds_read_b64_tr_b16 v[154:155], v10 offset:7680
ds_read_b64_tr_b16 v[156:157], v11 offset:6144
ds_read_b64_tr_b16 v[158:159], v11 offset:7680
s_add_u32 s54, s54, 12288
s_cmp_ge_u32 s54, 86016
s_cselect_b32 s58, s77, s76
s_cselect_b32 s54, 0, s54
v_add_u32 v2, s58, v2
v_add_u32 v3, s58, v3
v_add_u32 v4, s58, v4
v_add_u32 v5, s58, v5
v_add_u32 v6, s58, v6
v_add_u32 v7, s58, v7
v_add_u32 v8, s58, v8
v_add_u32 v9, s58, v9
v_add_u32 v10, s58, v10
v_add_u32 v11, s58, v11
s_waitcnt lgkmcnt(0)
Lmain_4:
v_mfma_f32_16x16x32_bf16 v[20:23], v[120:123], v[200:203], v[20:23]
ds_read_b128 v[208:211], v13 offset:0
ds_read_b128 v[212:215], v13 offset:2048
v_mfma_f32_16x16x32_bf16 v[60:63], v[120:123], v[204:207], v[60:63]
ds_read_b64_tr_b16 v[160:161], v2 offset:0
ds_read_b64_tr_b16 v[162:163], v2 offset:1536
v_mfma_f32_16x16x32_bf16 v[24:27], v[124:127], v[200:203], v[24:27]
ds_read_b64_tr_b16 v[164:165], v3 offset:0
ds_read_b64_tr_b16 v[166:167], v3 offset:1536
v_mfma_f32_16x16x32_bf16 v[64:67], v[124:127], v[204:207], v[64:67]
ds_read_b64_tr_b16 v[168:169], v4 offset:0
ds_read_b64_tr_b16 v[170:171], v4 offset:1536
v_mfma_f32_16x16x32_bf16 v[28:31], v[128:131], v[200:203], v[28:31]
ds_read_b64_tr_b16 v[172:173], v5 offset:0
ds_read_b64_tr_b16 v[174:175], v5 offset:1536
v_mfma_f32_16x16x32_bf16 v[68:71], v[128:131], v[204:207], v[68:71]
ds_read_b64_tr_b16 v[176:177], v6 offset:0
ds_read_b64_tr_b16 v[178:179], v6 offset:1536
v_mfma_f32_16x16x32_bf16 v[32:35], v[132:135], v[200:203], v[32:35]
ds_read_b64_tr_b16 v[180:181], v7 offset:6144
ds_read_b64_tr_b16 v[182:183], v7 offset:7680
v_mfma_f32_16x16x32_bf16 v[72:75], v[132:135], v[204:207], v[72:75]
ds_read_b64_tr_b16 v[184:185], v8 offset:6144
ds_read_b64_tr_b16 v[186:187], v8 offset:7680
v_mfma_f32_16x16x32_bf16 v[36:39], v[136:139], v[200:203], v[36:39]
ds_read_b64_tr_b16 v[188:189], v9 offset:6144
ds_read_b64_tr_b16 v[190:191], v9 offset:7680
v_mfma_f32_16x16x32_bf16 v[76:79], v[136:139], v[204:207], v[76:79]
ds_read_b64_tr_b16 v[192:193], v10 offset:6144
ds_read_b64_tr_b16 v[194:195], v10 offset:7680
v_mfma_f32_16x16x32_bf16 v[40:43], v[140:143], v[200:203], v[40:43]
ds_read_b64_tr_b16 v[196:197], v11 offset:6144
ds_read_b64_tr_b16 v[198:199], v11 offset:7680
v_mfma_f32_16x16x32_bf16 v[80:83], v[140:143], v[204:207], v[80:83]
s_add_u32 s54, s54, 12288
s_cmp_ge_u32 s54, 86016
s_cselect_b32 s58, s77, s76
s_cselect_b32 s54, 0, s54
v_add_u32 v2, s58, v2
v_mfma_f32_16x16x32_bf16 v[44:47], v[144:147], v[200:203], v[44:47]
v_add_u32 v3, s58, v3
v_add_u32 v4, s58, v4
v_mfma_f32_16x16x32_bf16 v[84:87], v[144:147], v[204:207], v[84:87]
v_add_u32 v5, s58, v5
v_add_u32 v6, s58, v6
v_mfma_f32_16x16x32_bf16 v[48:51], v[148:151], v[200:203], v[48:51]
v_add_u32 v7, s58, v7
v_add_u32 v8, s58, v8
v_mfma_f32_16x16x32_bf16 v[88:91], v[148:151], v[204:207], v[88:91]
v_add_u32 v9, s58, v9
v_add_u32 v10, s58, v10
v_mfma_f32_16x16x32_bf16 v[52:55], v[152:155], v[200:203], v[52:55]
v_add_u32 v11, s58, v11
s_add_u32 s55, s55, 16384
s_cmp_ge_u32 s55, 65536
s_cselect_b32 s56, s79, s78
s_cselect_b32 s55, 0, s55
v_mfma_f32_16x16x32_bf16 v[92:95], v[152:155], v[204:207], v[92:95]
v_add_u32 v12, s56, v12
v_add_u32 v13, s56, v13
v_mfma_f32_16x16x32_bf16 v[56:59], v[156:159], v[200:203], v[56:59]
v_mfma_f32_16x16x32_bf16 v[96:99], v[156:159], v[204:207], v[96:99]
s_waitcnt lgkmcnt(0)
s_barrier
v_mfma_f32_16x16x32_bf16 v[20:23], v[160:163], v[208:211], v[20:23]
ds_read_b128 v[200:203], v12 offset:0
ds_read_b128 v[204:207], v12 offset:2048
v_mfma_f32_16x16x32_bf16 v[60:63], v[160:163], v[212:215], v[60:63]
ds_read_b64_tr_b16 v[120:121], v2 offset:0
ds_read_b64_tr_b16 v[122:123], v2 offset:1536
v_mfma_f32_16x16x32_bf16 v[24:27], v[164:167], v[208:211], v[24:27]
ds_read_b64_tr_b16 v[124:125], v3 offset:0
ds_read_b64_tr_b16 v[126:127], v3 offset:1536
v_mfma_f32_16x16x32_bf16 v[64:67], v[164:167], v[212:215], v[64:67]
ds_read_b64_tr_b16 v[128:129], v4 offset:0
ds_read_b64_tr_b16 v[130:131], v4 offset:1536
v_mfma_f32_16x16x32_bf16 v[28:31], v[168:171], v[208:211], v[28:31]
ds_read_b64_tr_b16 v[132:133], v5 offset:0
ds_read_b64_tr_b16 v[134:135], v5 offset:1536
v_mfma_f32_16x16x32_bf16 v[68:71], v[168:171], v[212:215], v[68:71]
ds_read_b64_tr_b16 v[136:137], v6 offset:0
ds_read_b64_tr_b16 v[138:139], v6 offset:1536
v_mfma_f32_16x16x32_bf16 v[32:35], v[172:175], v[208:211], v[32:35]
ds_read_b64_tr_b16 v[140:141], v7 offset:6144
ds_read_b64_tr_b16 v[142:143], v7 offset:7680
v_mfma_f32_16x16x32_bf16 v[72:75], v[172:175], v[212:215], v[72:75]
ds_read_b64_tr_b16 v[144:145], v8 offset:6144
ds_read_b64_tr_b16 v[146:147], v8 offset:7680
v_mfma_f32_16x16x32_bf16 v[36:39], v[176:179], v[208:211], v[36:39]
ds_read_b64_tr_b16 v[148:149], v9 offset:6144
ds_read_b64_tr_b16 v[150:151], v9 offset:7680
v_mfma_f32_16x16x32_bf16 v[76:79], v[176:179], v[212:215], v[76:79]
ds_read_b64_tr_b16 v[152:153], v10 offset:6144
ds_read_b64_tr_b16 v[154:155], v10 offset:7680
v_mfma_f32_16x16x32_bf16 v[40:43], v[180:183], v[208:211], v[40:43]
ds_read_b64_tr_b16 v[156:157], v11 offset:6144
ds_read_b64_tr_b16 v[158:159], v11 offset:7680
v_mfma_f32_16x16x32_bf16 v[80:83], v[180:183], v[212:215], v[80:83]
s_add_u32 s54, s54, 12288
s_cmp_ge_u32 s54, 86016
s_cselect_b32 s58, s77, s76
s_cselect_b32 s54, 0, s54
v_add_u32 v2, s58, v2
v_mfma_f32_16x16x32_bf16 v[44:47], v[184:187], v[208:211], v[44:47]
v_add_u32 v3, s58, v3
v_add_u32 v4, s58, v4
v_mfma_f32_16x16x32_bf16 v[84:87], v[184:187], v[212:215], v[84:87]
v_add_u32 v5, s58, v5
v_add_u32 v6, s58, v6
v_mfma_f32_16x16x32_bf16 v[48:51], v[188:191], v[208:211], v[48:51]
v_add_u32 v7, s58, v7
v_add_u32 v8, s58, v8
v_mfma_f32_16x16x32_bf16 v[88:91], v[188:191], v[212:215], v[88:91]
v_add_u32 v9, s58, v9
v_add_u32 v10, s58, v10
v_mfma_f32_16x16x32_bf16 v[52:55], v[192:195], v[208:211], v[52:55]
v_add_u32 v11, s58, v11
v_mfma_f32_16x16x32_bf16 v[92:95], v[192:195], v[212:215], v[92:95]
v_mfma_f32_16x16x32_bf16 v[56:59], v[196:199], v[208:211], v[56:59]
v_mfma_f32_16x16x32_bf16 v[96:99], v[196:199], v[212:215], v[96:99]
s_cmp_lg_u32 s57, 0
s_cbranch_scc1 Lnozero_5
s_cmp_lg_u32 s59, 0
s_cbranch_scc1 Lnozero_5
s_cmp_lg_u32 s26, 0
s_cbranch_scc1 Lnozero_5
s_waitcnt vmcnt(0)
v_readfirstlane_b32 s60, v15
s_nop 3
s_cmp_lg_u32 s60, 0
s_cbranch_scc1 Lnozero_5
s_mov_b32 s63, 1
s_mov_b32 s72, s24
s_mov_b32 s73, s25
s_add_u32 s74, s62, 1
s_mul_i32 s74, s74, 13440
s_mov_b32 s75, 0x00020000
s_mul_i32 s60, s62, 13440
v_lshlrev_b32 v232, 4, v1
v_mov_b32 v236, 0
v_mov_b32 v237, 0
v_mov_b32 v238, 0
v_mov_b32 v239, 0
buffer_store_dwordx4 v[236:239], v232, s[72:75], s60 offen sc1
s_add_u32 s60, s60, 1024
buffer_store_dwordx4 v[236:239], v232, s[72:75], s60 offen sc1
s_add_u32 s60, s60, 1024
buffer_store_dwordx4 v[236:239], v232, s[72:75], s60 offen sc1
s_add_u32 s60, s60, 1024
buffer_store_dwordx4 v[236:239], v232, s[72:75], s60 offen sc1
s_add_u32 s60, s60, 1024
buffer_store_dwordx4 v[236:239], v232, s[72:75], s60 offen sc1
s_add_u32 s60, s60, 1024
buffer_store_dwordx4 v[236:239], v232, s[72:75], s60 offen sc1
s_add_u32 s60, s60, 1024
buffer_store_dwordx4 v[236:239], v232, s[72:75], s60 offen sc1
s_add_u32 s60, s60, 1024
buffer_store_dwordx4 v[236:239], v232, s[72:75], s60 offen sc1
s_add_u32 s60, s60, 1024
buffer_store_dwordx4 v[236:239], v232, s[72:75], s60 offen sc1
s_add_u32 s60, s60, 1024
buffer_store_dwordx4 v[236:239], v232, s[72:75], s60 offen sc1
s_add_u32 s60, s60, 1024
buffer_store_dwordx4 v[236:239], v232, s[72:75], s60 offen sc1
s_add_u32 s60, s60, 1024
buffer_store_dwordx4 v[236:239], v232, s[72:75], s60 offen sc1
s_add_u32 s60, s60, 1024
buffer_store_dwordx4 v[236:239], v232, s[72:75], s60 offen sc1
s_add_u32 s60, s60, 1024
buffer_store_dwordx4 v[236:239], v232, s[72:75], s60 offen sc1
s_add_u32 s60, s60, 1024
Lnozero_5:
s_cmp_lg_u32 s63, 1
s_cbranch_scc1 Lnoflag_6
s_cmp_lg_u32 s57, 2
s_cbranch_scc1 Lnoflag_6
s_waitcnt vmcnt(0)
s_lshl_b32 s60, s62, 2
s_add_u32 s60, s60, 32
v_mov_b32 v14, s60
v_mov_b32 v15, 1
s_mov_b64 exec, 1
buffer_store_dword v15, v14, s[48:51], 0 offen sc1
s_mov_b64 exec, -1
Lnoflag_6:
s_waitcnt lgkmcnt(0)
s_add_u32 s57, s57, 1
s_cmp_lt_u32 s57, 10
s_cbranch_scc1 Lmain_4
s_waitcnt vmcnt(0)
s_nop 7
v_and_b32 v232, 15, v1
v_lshrrev_b32 v233, 4, v1
v_lshlrev_b32 v234, 4, v233
s_mul_i32 s60, s26, 320
v_add_u32 v234, s60, v234
v_lshlrev_b32 v2, 4, v1
s_mul_i32 s60, s26, 10240
s_add_u32 s60, s60, 100352
v_add_u32 v2, s60, v2
s_cmp_eq_u32 s59, 0
s_cbranch_scc0 Lxq_7
ds_write_b128 v2, v[60:63] offset:0
ds_write_b128 v2, v[64:67] offset:1024
ds_write_b128 v2, v[68:71] offset:2048
ds_write_b128 v2, v[72:75] offset:3072
ds_write_b128 v2, v[76:79] offset:4096
s_branch Lxd_8
Lxq_7:
ds_write_b128 v2, v[40:43] offset:0
ds_write_b128 v2, v[44:47] offset:1024
ds_write_b128 v2, v[48:51] offset:2048
ds_write_b128 v2, v[52:55] offset:3072
ds_write_b128 v2, v[56:59] offset:4096
ds_write_b128 v2, v[80:83] offset:5120
ds_write_b128 v2, v[84:87] offset:6144
ds_write_b128 v2, v[88:91] offset:7168
ds_write_b128 v2, v[92:95] offset:8192
ds_write_b128 v2, v[96:99] offset:9216
Lxd_8:
s_mov_b32 s64, 0x3fb8aa3b
s_mov_b32 s65, 0xbfb8aa3b
s_mov_b32 s70, 0x3fb8aa3b
s_mov_b32 s71, 0x3fb8aa3b
v_lshrrev_b32 v232, 4, v1
v_and_b32 v233, 3, v1
v_bfe_u32 v234, v1, 2, 2
v_mul_u32_u24 v234, 40, v234
v_mul_u32_u24 v235, 800, v232
v_add_u32 v235, 0, v235
v_cmp_eq_u32 vcc, v232, v233
v_mov_b32 v236, 8192
s_nop 0
v_cndmask_b32 v235, v236, v235, vcc
v_add_u32 v14, v235, v234
ds_read_b64_tr_b16 v[120:121], v14 offset:0
ds_read_b64_tr_b16 v[122:123], v14 offset:160
ds_read_b64_tr_b16 v[124:125], v14 offset:320
ds_read_b64_tr_b16 v[126:127], v14 offset:480
ds_read_b64_tr_b16 v[128:129], v14 offset:640
ds_read_b64_tr_b16 v[130:131], v14 offset:8
ds_read_b64_tr_b16 v[132:133], v14 offset:168
ds_read_b64_tr_b16 v[134:135], v14 offset:328
ds_read_b64_tr_b16 v[136:137], v14 offset:488
ds_read_b64_tr_b16 v[138:139], v14 offset:648
ds_read_b64_tr_b16 v[140:141], v14 offset:16
ds_read_b64_tr_b16 v[142:143], v14 offset:176
ds_read_b64_tr_b16 v[144:145], v14 offset:336
ds_read_b64_tr_b16 v[146:147], v14 offset:496
ds_read_b64_tr_b16 v[148:149], v14 offset:656
ds_read_b64_tr_b16 v[150:151], v14 offset:24
ds_read_b64_tr_b16 v[152:153], v14 offset:184
ds_read_b64_tr_b16 v[154:155], v14 offset:344
ds_read_b64_tr_b16 v[156:157], v14 offset:504
ds_read_b64_tr_b16 v[158:159], v14 offset:664
ds_read_b64_tr_b16 v[160:161], v14 offset:32
ds_read_b64_tr_b16 v[162:163], v14 offset:192
ds_read_b64_tr_b16 v[164:165], v14 offset:352
ds_read_b64_tr_b16 v[166:167], v14 offset:512
ds_read_b64_tr_b16 v[168:169], v14 offset:672
s_waitcnt lgkmcnt(0)
s_barrier
s_cmp_eq_u32 s59, 0
s_cbranch_scc0 Lp1_epi_q
s_lshl_b32 s68, s62, 2
s_add_u32 s68, s68, 32
v_mov_b32 v246, s68
buffer_load_dword v247, v246, s[48:51], 0 offen sc1
v_and_b32 v232, 15, v1
v_lshlrev_b32 v232, 3, v232
s_lshl_b32 s60, s26, 8
v_add_u32 v232, s60, v232
ds_read_b64 v[230:231], v232 offset:10496
ds_read_b64 v[240:241], v232 offset:10624
v_and_b32 v232, 15, v1
v_lshrrev_b32 v233, 4, v1
s_lshl_b32 s60, s26, 5
v_add_u32 v232, s60, v232
v_mul_u32_u24 v234, 352, v232
v_mul_u32_u24 v235, 80, v233
v_add_u32 v248, v234, v235
v_mul_u32_u24 v234, 224, v232
v_mul_u32_u24 v235, 48, v233
v_add_u32 v249, v234, v235
v_add_u32 v249, 57344, v249
v_lshrrev_b32 v233, 4, v1
v_lshlrev_b32 v234, 4, v233
ds_read_b128 v[170:173], v234 offset:9856
ds_read_b128 v[190:193], v234 offset:10176
ds_read_b128 v[174:177], v234 offset:9920
ds_read_b128 v[194:197], v234 offset:10240
ds_read_b128 v[178:181], v234 offset:9984
ds_read_b128 v[198:201], v234 offset:10304
ds_read_b128 v[182:185], v234 offset:10048
ds_read_b128 v[202:205], v234 offset:10368
ds_read_b128 v[186:189], v234 offset:10112
ds_read_b128 v[206:209], v234 offset:10432
s_waitcnt lgkmcnt(0)
v_pk_add_f32 v[170:171], v[170:171], v[190:191]
v_pk_add_f32 v[172:173], v[172:173], v[192:193]
v_pk_add_f32 v[174:175], v[174:175], v[194:195]
v_pk_add_f32 v[176:177], v[176:177], v[196:197]
v_pk_add_f32 v[178:179], v[178:179], v[198:199]
v_pk_add_f32 v[180:181], v[180:181], v[200:201]
v_pk_add_f32 v[182:183], v[182:183], v[202:203]
v_pk_add_f32 v[184:185], v[184:185], v[204:205]
v_pk_add_f32 v[186:187], v[186:187], v[206:207]
v_pk_add_f32 v[188:189], v[188:189], v[208:209]
v_pk_mul_f32 v[206:207], v[170:171], v[230:231] op_sel:[0,1] op_sel_hi:[1,1]
v_pk_fma_f32 v[40:41], v[40:41], v[230:231], v[206:207] op_sel_hi:[1,0,1]
v_pk_mul_f32 v[206:207], v[172:173], v[230:231] op_sel:[0,1] op_sel_hi:[1,1]
v_pk_fma_f32 v[42:43], v[42:43], v[230:231], v[206:207] op_sel_hi:[1,0,1]
v_pk_mul_f32 v[206:207], v[174:175], v[230:231] op_sel:[0,1] op_sel_hi:[1,1]
v_pk_fma_f32 v[44:45], v[44:45], v[230:231], v[206:207] op_sel_hi:[1,0,1]
v_pk_mul_f32 v[206:207], v[176:177], v[230:231] op_sel:[0,1] op_sel_hi:[1,1]
v_pk_fma_f32 v[46:47], v[46:47], v[230:231], v[206:207] op_sel_hi:[1,0,1]
v_pk_mul_f32 v[206:207], v[178:179], v[230:231] op_sel:[0,1] op_sel_hi:[1,1]
v_pk_fma_f32 v[48:49], v[48:49], v[230:231], v[206:207] op_sel_hi:[1,0,1]
v_pk_mul_f32 v[206:207], v[180:181], v[230:231] op_sel:[0,1] op_sel_hi:[1,1]
v_pk_fma_f32 v[50:51], v[50:51], v[230:231], v[206:207] op_sel_hi:[1,0,1]
v_pk_mul_f32 v[206:207], v[182:183], v[230:231] op_sel:[0,1] op_sel_hi:[1,1]
v_pk_fma_f32 v[52:53], v[52:53], v[230:231], v[206:207] op_sel_hi:[1,0,1]
v_pk_mul_f32 v[206:207], v[184:185], v[230:231] op_sel:[0,1] op_sel_hi:[1,1]
v_pk_fma_f32 v[54:55], v[54:55], v[230:231], v[206:207] op_sel_hi:[1,0,1]
v_pk_mul_f32 v[206:207], v[186:187], v[230:231] op_sel:[0,1] op_sel_hi:[1,1]
v_pk_fma_f32 v[56:57], v[56:57], v[230:231], v[206:207] op_sel_hi:[1,0,1]
v_pk_mul_f32 v[206:207], v[188:189], v[230:231] op_sel:[0,1] op_sel_hi:[1,1]
v_pk_fma_f32 v[58:59], v[58:59], v[230:231], v[206:207] op_sel_hi:[1,0,1]
v_cvt_pk_bf16_f32 v210, v40, v41
v_cvt_pk_bf16_f32 v211, v42, v43
v_cvt_pk_bf16_f32 v212, v44, v45
v_cvt_pk_bf16_f32 v213, v46, v47
v_cvt_pk_bf16_f32 v214, v48, v49
v_cvt_pk_bf16_f32 v215, v50, v51
v_cvt_pk_bf16_f32 v216, v52, v53
v_cvt_pk_bf16_f32 v217, v54, v55
v_cvt_pk_bf16_f32 v218, v56, v57
v_cvt_pk_bf16_f32 v219, v58, v59
v_mov_b32 v220, 0x3f80
v_mov_b32 v221, 0
ds_write_b128 v249, v[210:213] offset:0
ds_write_b128 v249, v[214:217] offset:16
ds_write_b128 v249, v[218:221] offset:32
s_nop 1
v_pk_mul_f32 v[206:207], v[170:171], v[240:241] op_sel:[0,1] op_sel_hi:[1,1]
v_pk_fma_f32 v[80:81], v[80:81], v[240:241], v[206:207] op_sel_hi:[1,0,1]
v_pk_mul_f32 v[206:207], v[172:173], v[240:241] op_sel:[0,1] op_sel_hi:[1,1]
v_pk_fma_f32 v[82:83], v[82:83], v[240:241], v[206:207] op_sel_hi:[1,0,1]
v_pk_mul_f32 v[206:207], v[174:175], v[240:241] op_sel:[0,1] op_sel_hi:[1,1]
v_pk_fma_f32 v[84:85], v[84:85], v[240:241], v[206:207] op_sel_hi:[1,0,1]
v_pk_mul_f32 v[206:207], v[176:177], v[240:241] op_sel:[0,1] op_sel_hi:[1,1]
v_pk_fma_f32 v[86:87], v[86:87], v[240:241], v[206:207] op_sel_hi:[1,0,1]
v_pk_mul_f32 v[206:207], v[178:179], v[240:241] op_sel:[0,1] op_sel_hi:[1,1]
v_pk_fma_f32 v[88:89], v[88:89], v[240:241], v[206:207] op_sel_hi:[1,0,1]
v_pk_mul_f32 v[206:207], v[180:181], v[240:241] op_sel:[0,1] op_sel_hi:[1,1]
v_pk_fma_f32 v[90:91], v[90:91], v[240:241], v[206:207] op_sel_hi:[1,0,1]
v_pk_mul_f32 v[206:207], v[182:183], v[240:241] op_sel:[0,1] op_sel_hi:[1,1]
v_pk_fma_f32 v[92:93], v[92:93], v[240:241], v[206:207] op_sel_hi:[1,0,1]
v_pk_mul_f32 v[206:207], v[184:185], v[240:241] op_sel:[0,1] op_sel_hi:[1,1]
v_pk_fma_f32 v[94:95], v[94:95], v[240:241], v[206:207] op_sel_hi:[1,0,1]
v_pk_mul_f32 v[206:207], v[186:187], v[240:241] op_sel:[0,1] op_sel_hi:[1,1]
v_pk_fma_f32 v[96:97], v[96:97], v[240:241], v[206:207] op_sel_hi:[1,0,1]
v_pk_mul_f32 v[206:207], v[188:189], v[240:241] op_sel:[0,1] op_sel_hi:[1,1]
v_pk_fma_f32 v[98:99], v[98:99], v[240:241], v[206:207] op_sel_hi:[1,0,1]
v_cvt_pk_bf16_f32 v210, v80, v81
v_cvt_pk_bf16_f32 v211, v82, v83
v_cvt_pk_bf16_f32 v212, v84, v85
v_cvt_pk_bf16_f32 v213, v86, v87
v_cvt_pk_bf16_f32 v214, v88, v89
v_cvt_pk_bf16_f32 v215, v90, v91
v_cvt_pk_bf16_f32 v216, v92, v93
v_cvt_pk_bf16_f32 v217, v94, v95
v_cvt_pk_bf16_f32 v218, v96, v97
v_cvt_pk_bf16_f32 v219, v98, v99
v_mov_b32 v220, 0x3f80
v_mov_b32 v221, 0
ds_write_b128 v249, v[210:213] offset:3584
ds_write_b128 v249, v[214:217] offset:3600
ds_write_b128 v249, v[218:221] offset:3616
s_nop 1
v_lshrrev_b32 v233, 4, v1
v_lshlrev_b32 v234, 4, v233
ds_read_b128 v[170:173], v234 offset:9216
ds_read_b128 v[190:193], v234 offset:9536
ds_read_b128 v[174:177], v234 offset:9280
ds_read_b128 v[194:197], v234 offset:9600
ds_read_b128 v[178:181], v234 offset:9344
ds_read_b128 v[198:201], v234 offset:9664
ds_read_b128 v[182:185], v234 offset:9408
ds_read_b128 v[202:205], v234 offset:9728
ds_read_b128 v[186:189], v234 offset:9472
ds_read_b128 v[206:209], v234 offset:9792
s_waitcnt lgkmcnt(0)
v_pk_add_f32 v[170:171], v[170:171], v[190:191]
v_pk_add_f32 v[172:173], v[172:173], v[192:193]
v_pk_add_f32 v[174:175], v[174:175], v[194:195]
v_pk_add_f32 v[176:177], v[176:177], v[196:197]
v_pk_add_f32 v[178:179], v[178:179], v[198:199]
v_pk_add_f32 v[180:181], v[180:181], v[200:201]
v_pk_add_f32 v[182:183], v[182:183], v[202:203]
v_pk_add_f32 v[184:185], v[184:185], v[204:205]
v_pk_add_f32 v[186:187], v[186:187], v[206:207]
v_pk_add_f32 v[188:189], v[188:189], v[208:209]
v_pk_mul_f32 v[206:207], v[170:171], v[230:231] op_sel:[0,1] op_sel_hi:[1,1]
v_pk_fma_f32 v[20:21], v[20:21], v[230:231], v[206:207] op_sel_hi:[1,0,1]
v_pk_mul_f32 v[206:207], v[172:173], v[230:231] op_sel:[0,1] op_sel_hi:[1,1]
v_pk_fma_f32 v[22:23], v[22:23], v[230:231], v[206:207] op_sel_hi:[1,0,1]
v_pk_mul_f32 v[206:207], v[174:175], v[230:231] op_sel:[0,1] op_sel_hi:[1,1]
v_pk_fma_f32 v[24:25], v[24:25], v[230:231], v[206:207] op_sel_hi:[1,0,1]
v_pk_mul_f32 v[206:207], v[176:177], v[230:231] op_sel:[0,1] op_sel_hi:[1,1]
v_pk_fma_f32 v[26:27], v[26:27], v[230:231], v[206:207] op_sel_hi:[1,0,1]
v_pk_mul_f32 v[206:207], v[178:179], v[230:231] op_sel:[0,1] op_sel_hi:[1,1]
v_pk_fma_f32 v[28:29], v[28:29], v[230:231], v[206:207] op_sel_hi:[1,0,1]
v_pk_mul_f32 v[206:207], v[180:181], v[230:231] op_sel:[0,1] op_sel_hi:[1,1]
v_pk_fma_f32 v[30:31], v[30:31], v[230:231], v[206:207] op_sel_hi:[1,0,1]
v_pk_mul_f32 v[206:207], v[182:183], v[230:231] op_sel:[0,1] op_sel_hi:[1,1]
v_pk_fma_f32 v[32:33], v[32:33], v[230:231], v[206:207] op_sel_hi:[1,0,1]
v_pk_mul_f32 v[206:207], v[184:185], v[230:231] op_sel:[0,1] op_sel_hi:[1,1]
v_pk_fma_f32 v[34:35], v[34:35], v[230:231], v[206:207] op_sel_hi:[1,0,1]
v_pk_mul_f32 v[206:207], v[186:187], v[230:231] op_sel:[0,1] op_sel_hi:[1,1]
v_pk_fma_f32 v[36:37], v[36:37], v[230:231], v[206:207] op_sel_hi:[1,0,1]
v_pk_mul_f32 v[206:207], v[188:189], v[230:231] op_sel:[0,1] op_sel_hi:[1,1]
v_pk_fma_f32 v[38:39], v[38:39], v[230:231], v[206:207] op_sel_hi:[1,0,1]
v_cvt_pk_bf16_f32 v190, v20, v21
v_cvt_pk_bf16_f32 v191, v22, v23
v_cvt_pk_bf16_f32 v192, v24, v25
v_cvt_pk_bf16_f32 v193, v26, v27
v_cvt_pk_bf16_f32 v194, v28, v29
v_cvt_pk_bf16_f32 v195, v30, v31
v_cvt_pk_bf16_f32 v196, v32, v33
v_cvt_pk_bf16_f32 v197, v34, v35
v_cvt_pk_bf16_f32 v198, v36, v37
v_cvt_pk_bf16_f32 v199, v38, v39
s_nop 1
v_mfma_f32_16x16x32_bf16 v[100:103], v[120:123], v[190:193], 0
v_mfma_f32_16x16x32_bf16 v[104:107], v[130:133], v[190:193], 0
v_mfma_f32_16x16x32_bf16 v[108:111], v[140:143], v[190:193], 0
v_mfma_f32_16x16x32_bf16 v[112:115], v[150:153], v[190:193], 0
v_mfma_f32_16x16x32_bf16 v[116:119], v[160:163], v[190:193], 0
v_mfma_f32_16x16x32_bf16 v[100:103], v[124:127], v[194:197], v[100:103]
v_mfma_f32_16x16x32_bf16 v[104:107], v[134:137], v[194:197], v[104:107]
v_mfma_f32_16x16x32_bf16 v[108:111], v[144:147], v[194:197], v[108:111]
v_mfma_f32_16x16x32_bf16 v[112:115], v[154:157], v[194:197], v[112:115]
v_mfma_f32_16x16x32_bf16 v[116:119], v[164:167], v[194:197], v[116:119]
v_mfma_f32_16x16x16_bf16 v[100:103], v[128:129], v[198:199], v[100:103]
v_mfma_f32_16x16x16_bf16 v[104:107], v[138:139], v[198:199], v[104:107]
v_mfma_f32_16x16x16_bf16 v[108:111], v[148:149], v[198:199], v[108:111]
v_mfma_f32_16x16x16_bf16 v[112:115], v[158:159], v[198:199], v[112:115]
v_mfma_f32_16x16x16_bf16 v[116:119], v[168:169], v[198:199], v[116:119]
s_nop 7
v_max3_f32 v250, v100, v101, v102
v_min3_f32 v252, v100, v101, v102
v_max3_f32 v250, v250, v103, v104
v_min3_f32 v252, v252, v103, v104
v_max3_f32 v250, v250, v105, v106
v_min3_f32 v252, v252, v105, v106
v_max3_f32 v250, v250, v107, v108
v_min3_f32 v252, v252, v107, v108
v_max3_f32 v250, v250, v109, v110
v_min3_f32 v252, v252, v109, v110
v_max3_f32 v250, v250, v111, v112
v_min3_f32 v252, v252, v111, v112
v_max3_f32 v250, v250, v113, v114
v_min3_f32 v252, v252, v113, v114
v_max3_f32 v250, v250, v115, v116
v_min3_f32 v252, v252, v115, v116
v_max3_f32 v250, v250, v117, v118
v_min3_f32 v252, v252, v117, v118
v_max_f32 v250, v250, v119
v_min_f32 v252, v252, v119
v_mul_f32 v250, s65, v250
v_mul_f32 v252, s64, v252
v_pk_fma_f32 v[210:211], v[100:101], s[70:71], v[250:251] op_sel_hi:[1,1,0]
v_pk_fma_f32 v[100:101], v[100:101], s[70:71], v[252:253] op_sel_hi:[1,1,0] neg_lo:[1,0,0] neg_hi:[1,0,0]
v_pk_fma_f32 v[212:213], v[102:103], s[70:71], v[250:251] op_sel_hi:[1,1,0]
v_pk_fma_f32 v[102:103], v[102:103], s[70:71], v[252:253] op_sel_hi:[1,1,0] neg_lo:[1,0,0] neg_hi:[1,0,0]
v_pk_fma_f32 v[214:215], v[104:105], s[70:71], v[250:251] op_sel_hi:[1,1,0]
v_pk_fma_f32 v[104:105], v[104:105], s[70:71], v[252:253] op_sel_hi:[1,1,0] neg_lo:[1,0,0] neg_hi:[1,0,0]
v_pk_fma_f32 v[216:217], v[106:107], s[70:71], v[250:251] op_sel_hi:[1,1,0]
v_pk_fma_f32 v[106:107], v[106:107], s[70:71], v[252:253] op_sel_hi:[1,1,0] neg_lo:[1,0,0] neg_hi:[1,0,0]
v_pk_fma_f32 v[218:219], v[108:109], s[70:71], v[250:251] op_sel_hi:[1,1,0]
v_pk_fma_f32 v[108:109], v[108:109], s[70:71], v[252:253] op_sel_hi:[1,1,0] neg_lo:[1,0,0] neg_hi:[1,0,0]
v_pk_fma_f32 v[220:221], v[110:111], s[70:71], v[250:251] op_sel_hi:[1,1,0]
v_pk_fma_f32 v[110:111], v[110:111], s[70:71], v[252:253] op_sel_hi:[1,1,0] neg_lo:[1,0,0] neg_hi:[1,0,0]
v_pk_fma_f32 v[222:223], v[112:113], s[70:71], v[250:251] op_sel_hi:[1,1,0]
v_pk_fma_f32 v[112:113], v[112:113], s[70:71], v[252:253] op_sel_hi:[1,1,0] neg_lo:[1,0,0] neg_hi:[1,0,0]
v_pk_fma_f32 v[224:225], v[114:115], s[70:71], v[250:251] op_sel_hi:[1,1,0]
v_pk_fma_f32 v[114:115], v[114:115], s[70:71], v[252:253] op_sel_hi:[1,1,0] neg_lo:[1,0,0] neg_hi:[1,0,0]
v_pk_fma_f32 v[226:227], v[116:117], s[70:71], v[250:251] op_sel_hi:[1,1,0]
v_pk_fma_f32 v[116:117], v[116:117], s[70:71], v[252:253] op_sel_hi:[1,1,0] neg_lo:[1,0,0] neg_hi:[1,0,0]
v_pk_fma_f32 v[228:229], v[118:119], s[70:71], v[250:251] op_sel_hi:[1,1,0]
v_pk_fma_f32 v[118:119], v[118:119], s[70:71], v[252:253] op_sel_hi:[1,1,0] neg_lo:[1,0,0] neg_hi:[1,0,0]
v_exp_f32 v210, v210
v_exp_f32 v100, v100
v_exp_f32 v211, v211
v_exp_f32 v101, v101
v_exp_f32 v212, v212
v_exp_f32 v102, v102
v_exp_f32 v213, v213
v_exp_f32 v103, v103
v_exp_f32 v214, v214
v_exp_f32 v104, v104
v_exp_f32 v215, v215
v_exp_f32 v105, v105
v_exp_f32 v216, v216
v_exp_f32 v106, v106
v_exp_f32 v217, v217
v_exp_f32 v107, v107
v_exp_f32 v218, v218
v_exp_f32 v108, v108
v_exp_f32 v219, v219
v_exp_f32 v109, v109
v_exp_f32 v220, v220
v_exp_f32 v110, v110
v_exp_f32 v221, v221
v_exp_f32 v111, v111
v_exp_f32 v222, v222
v_exp_f32 v112, v112
v_exp_f32 v223, v223
v_exp_f32 v113, v113
v_exp_f32 v224, v224
v_exp_f32 v114, v114
v_exp_f32 v225, v225
v_exp_f32 v115, v115
v_exp_f32 v226, v226
v_exp_f32 v116, v116
v_exp_f32 v227, v227
v_exp_f32 v117, v117
v_exp_f32 v228, v228
v_exp_f32 v118, v118
v_exp_f32 v229, v229
v_exp_f32 v119, v119
s_nop 0
v_pk_add_f32 v[250:251], v[210:211], v[212:213]
v_pk_add_f32 v[252:253], v[100:101], v[102:103]
v_pk_add_f32 v[250:251], v[250:251], v[214:215]
v_pk_add_f32 v[252:253], v[252:253], v[104:105]
v_pk_add_f32 v[250:251], v[250:251], v[216:217]
v_pk_add_f32 v[252:253], v[252:253], v[106:107]
v_pk_add_f32 v[250:251], v[250:251], v[218:219]
v_pk_add_f32 v[252:253], v[252:253], v[108:109]
v_pk_add_f32 v[250:251], v[250:251], v[220:221]
v_pk_add_f32 v[252:253], v[252:253], v[110:111]
v_pk_add_f32 v[250:251], v[250:251], v[222:223]
v_pk_add_f32 v[252:253], v[252:253], v[112:113]
v_pk_add_f32 v[250:251], v[250:251], v[224:225]
v_pk_add_f32 v[252:253], v[252:253], v[114:115]
v_pk_add_f32 v[250:251], v[250:251], v[226:227]
v_pk_add_f32 v[252:253], v[252:253], v[116:117]
v_pk_add_f32 v[250:251], v[250:251], v[228:229]
v_pk_add_f32 v[252:253], v[252:253], v[118:119]
v_add_f32 v250, v250, v251
v_add_f32 v252, v252, v253
v_rcp_f32 v250, v250
v_rcp_f32 v252, v252
s_nop 0
v_pk_mul_f32 v[210:211], v[210:211], v[250:251] op_sel_hi:[1,0]
v_pk_mul_f32 v[100:101], v[100:101], v[252:253] op_sel_hi:[1,0]
v_pk_mul_f32 v[212:213], v[212:213], v[250:251] op_sel_hi:[1,0]
v_pk_mul_f32 v[102:103], v[102:103], v[252:253] op_sel_hi:[1,0]
v_pk_mul_f32 v[214:215], v[214:215], v[250:251] op_sel_hi:[1,0]
v_pk_mul_f32 v[104:105], v[104:105], v[252:253] op_sel_hi:[1,0]
v_pk_mul_f32 v[216:217], v[216:217], v[250:251] op_sel_hi:[1,0]
v_pk_mul_f32 v[106:107], v[106:107], v[252:253] op_sel_hi:[1,0]
v_pk_mul_f32 v[218:219], v[218:219], v[250:251] op_sel_hi:[1,0]
v_pk_mul_f32 v[108:109], v[108:109], v[252:253] op_sel_hi:[1,0]
v_pk_mul_f32 v[220:221], v[220:221], v[250:251] op_sel_hi:[1,0]
v_pk_mul_f32 v[110:111], v[110:111], v[252:253] op_sel_hi:[1,0]
v_pk_mul_f32 v[222:223], v[222:223], v[250:251] op_sel_hi:[1,0]
v_pk_mul_f32 v[112:113], v[112:113], v[252:253] op_sel_hi:[1,0]
v_pk_mul_f32 v[224:225], v[224:225], v[250:251] op_sel_hi:[1,0]
v_pk_mul_f32 v[114:115], v[114:115], v[252:253] op_sel_hi:[1,0]
v_pk_mul_f32 v[226:227], v[226:227], v[250:251] op_sel_hi:[1,0]
v_pk_mul_f32 v[116:117], v[116:117], v[252:253] op_sel_hi:[1,0]
v_pk_mul_f32 v[228:229], v[228:229], v[250:251] op_sel_hi:[1,0]
v_pk_mul_f32 v[118:119], v[118:119], v[252:253] op_sel_hi:[1,0]
v_cvt_pk_bf16_f32 v20, v210, v211
v_cvt_pk_bf16_f32 v30, v100, v101
v_cvt_pk_bf16_f32 v21, v212, v213
v_cvt_pk_bf16_f32 v31, v102, v103
v_cvt_pk_bf16_f32 v22, v214, v215
v_cvt_pk_bf16_f32 v32, v104, v105
v_cvt_pk_bf16_f32 v23, v216, v217
v_cvt_pk_bf16_f32 v33, v106, v107
v_cvt_pk_bf16_f32 v24, v218, v219
v_cvt_pk_bf16_f32 v34, v108, v109
v_cvt_pk_bf16_f32 v25, v220, v221
v_cvt_pk_bf16_f32 v35, v110, v111
v_cvt_pk_bf16_f32 v26, v222, v223
v_cvt_pk_bf16_f32 v36, v112, v113
v_cvt_pk_bf16_f32 v27, v224, v225
v_cvt_pk_bf16_f32 v37, v114, v115
v_cvt_pk_bf16_f32 v28, v226, v227
v_cvt_pk_bf16_f32 v38, v116, v117
v_cvt_pk_bf16_f32 v29, v228, v229
v_cvt_pk_bf16_f32 v39, v118, v119
ds_write_b128 v248, v[20:23] offset:12288
ds_write_b128 v248, v[24:27] offset:12304
ds_write_b128 v248, v[28:31] offset:12320
ds_write_b128 v248, v[32:35] offset:12336
ds_write_b128 v248, v[36:39] offset:12352
s_waitcnt lgkmcnt(0)
s_barrier
v_lshrrev_b32 v232, 4, v1
v_lshlrev_b32 v232, 2, v232
v_bfe_u32 v233, v1, 2, 2
v_add_u32 v232, v232, v233
v_and_b32 v233, 3, v1
v_lshlrev_b32 v233, 3, v233
v_mul_u32_u24 v234, 352, v232
v_add_u32 v234, v234, v233
s_mul_i32 s60, s26, 80
v_add_u32 v234, s60, v234
v_mul_u32_u24 v235, 224, v232
v_add_u32 v235, v235, v233
s_mul_i32 s60, s26, 48
v_add_u32 v235, s60, v235
v_add_u32 v235, 57344, v235
ds_read_b64_tr_b16 v[136:137], v234 offset:12288
ds_read_b64_tr_b16 v[138:139], v234 offset:17920
ds_read_b64_tr_b16 v[140:141], v234 offset:12320
ds_read_b64_tr_b16 v[142:143], v234 offset:17952
ds_read_b64_tr_b16 v[144:145], v234 offset:12352
ds_read_b64_tr_b16 v[146:147], v234 offset:17984
ds_read_b64_tr_b16 v[184:185], v235 offset:0
ds_read_b64_tr_b16 v[186:187], v235 offset:3584
ds_read_b64_tr_b16 v[188:189], v235 offset:32
ds_read_b64_tr_b16 v[190:191], v235 offset:3616
ds_read_b64_tr_b16 v[148:149], v234 offset:23552
ds_read_b64_tr_b16 v[150:151], v234 offset:29184
ds_read_b64_tr_b16 v[152:153], v234 offset:23584
ds_read_b64_tr_b16 v[154:155], v234 offset:29216
ds_read_b64_tr_b16 v[156:157], v234 offset:23616
ds_read_b64_tr_b16 v[158:159], v234 offset:29248
ds_read_b64_tr_b16 v[192:193], v235 offset:7168
ds_read_b64_tr_b16 v[194:195], v235 offset:10752
ds_read_b64_tr_b16 v[196:197], v235 offset:7200
ds_read_b64_tr_b16 v[198:199], v235 offset:10784
ds_read_b64_tr_b16 v[160:161], v234 offset:34816
ds_read_b64_tr_b16 v[162:163], v234 offset:40448
ds_read_b64_tr_b16 v[164:165], v234 offset:34848
ds_read_b64_tr_b16 v[166:167], v234 offset:40480
ds_read_b64_tr_b16 v[168:169], v234 offset:34880
ds_read_b64_tr_b16 v[170:171], v234 offset:40512
ds_read_b64_tr_b16 v[200:201], v235 offset:14336
ds_read_b64_tr_b16 v[202:203], v235 offset:17920
ds_read_b64_tr_b16 v[204:205], v235 offset:14368
ds_read_b64_tr_b16 v[206:207], v235 offset:17952
ds_read_b64_tr_b16 v[172:173], v234 offset:46080
ds_read_b64_tr_b16 v[174:175], v234 offset:51712
ds_read_b64_tr_b16 v[176:177], v234 offset:46112
ds_read_b64_tr_b16 v[178:179], v234 offset:51744
ds_read_b64_tr_b16 v[180:181], v234 offset:46144
ds_read_b64_tr_b16 v[182:183], v234 offset:51776
ds_read_b64_tr_b16 v[208:209], v235 offset:21504
ds_read_b64_tr_b16 v[210:211], v235 offset:25088
ds_read_b64_tr_b16 v[212:213], v235 offset:21536
ds_read_b64_tr_b16 v[214:215], v235 offset:25120
s_waitcnt lgkmcnt(0)
v_mfma_f32_16x16x32_bf16 v[100:103], v[136:139], v[184:187], 0
v_mfma_f32_16x16x32_bf16 v[104:107], v[136:139], v[188:191], 0
v_mfma_f32_16x16x32_bf16 v[108:111], v[140:143], v[184:187], 0
v_mfma_f32_16x16x32_bf16 v[112:115], v[140:143], v[188:191], 0
v_mfma_f32_16x16x32_bf16 v[116:119], v[144:147], v[184:187], 0
v_mfma_f32_16x16x32_bf16 v[120:123], v[144:147], v[188:191], 0
s_waitcnt lgkmcnt(0)
v_mfma_f32_16x16x32_bf16 v[100:103], v[148:151], v[192:195], v[100:103]
v_mfma_f32_16x16x32_bf16 v[104:107], v[148:151], v[196:199], v[104:107]
v_mfma_f32_16x16x32_bf16 v[108:111], v[152:155], v[192:195], v[108:111]
v_mfma_f32_16x16x32_bf16 v[112:115], v[152:155], v[196:199], v[112:115]
v_mfma_f32_16x16x32_bf16 v[116:119], v[156:159], v[192:195], v[116:119]
v_mfma_f32_16x16x32_bf16 v[120:123], v[156:159], v[196:199], v[120:123]
s_waitcnt lgkmcnt(10)
v_mfma_f32_16x16x32_bf16 v[100:103], v[160:163], v[200:203], v[100:103]
v_mfma_f32_16x16x32_bf16 v[104:107], v[160:163], v[204:207], v[104:107]
v_mfma_f32_16x16x32_bf16 v[108:111], v[164:167], v[200:203], v[108:111]
v_mfma_f32_16x16x32_bf16 v[112:115], v[164:167], v[204:207], v[112:115]
v_mfma_f32_16x16x32_bf16 v[116:119], v[168:171], v[200:203], v[116:119]
v_mfma_f32_16x16x32_bf16 v[120:123], v[168:171], v[204:207], v[120:123]
s_waitcnt lgkmcnt(0)
v_mfma_f32_16x16x32_bf16 v[100:103], v[172:175], v[208:211], v[100:103]
v_mfma_f32_16x16x32_bf16 v[104:107], v[172:175], v[212:215], v[104:107]
v_mfma_f32_16x16x32_bf16 v[108:111], v[176:179], v[208:211], v[108:111]
v_mfma_f32_16x16x32_bf16 v[112:115], v[176:179], v[212:215], v[112:115]
v_mfma_f32_16x16x32_bf16 v[116:119], v[180:183], v[208:211], v[116:119]
v_mfma_f32_16x16x32_bf16 v[120:123], v[180:183], v[212:215], v[120:123]
v_and_b32 v232, 15, v1
v_lshrrev_b32 v233, 4, v1
v_and_b32 v234, 1, v233
v_lshrrev_b32 v235, 1, v233
v_lshlrev_b32 v236, 1, v234
v_add_u32 v236, v236, v235
v_mul_u32_u24 v236, 336, v236
v_lshlrev_b32 v237, 4, v232
v_add_u32 v236, v236, v237
s_mul_i32 s60, s26, 3360
s_add_u32 s61, s60, 86016
v_add_u32 v236, s61, v236
v_mul_u32_u24 v238, 336, v234
v_add_u32 v238, v238, v237
v_add_u32 v238, s61, v238
v_cmp_gt_u32 s[68:69], 5, v232
v_cmp_eq_u32 s[70:71], 0, v235
s_and_b64 s[72:73], s[68:69], s[70:71]
ds_write_b128 v236, v[100:103] offset:0
ds_write_b128 v236, v[108:111] offset:1344
s_mov_b64 exec, s[68:69]
ds_write_b128 v236, v[104:107] offset:256
ds_write_b128 v236, v[112:115] offset:1600
s_mov_b64 exec, s[70:71]
ds_write_b128 v238, v[116:119] offset:2688
s_mov_b64 exec, s[72:73]
ds_write_b128 v238, v[120:123] offset:2944
s_mov_b64 exec, -1
v_lshlrev_b32 v232, 2, v1
v_add_u32 v233, s61, v232
s_waitcnt lgkmcnt(0)
ds_read_b32 v136, v233 offset:0
ds_read_b32 v137, v233 offset:256
ds_read_b32 v138, v233 offset:512
ds_read_b32 v139, v233 offset:768
ds_read_b32 v140, v233 offset:1024
ds_read_b32 v141, v233 offset:1280
ds_read_b32 v142, v233 offset:1536
ds_read_b32 v143, v233 offset:1792
ds_read_b32 v144, v233 offset:2048
ds_read_b32 v145, v233 offset:2304
ds_read_b32 v146, v233 offset:2560
ds_read_b32 v147, v233 offset:2816
ds_read_b32 v148, v233 offset:3072
ds_read_b32 v149, v233 offset:3328
Lpoll_9:
s_waitcnt vmcnt(0)
v_readfirstlane_b32 s69, v247
s_nop 3
s_cmp_lg_u32 s69, 0
s_cbranch_scc1 Lpolld_10
buffer_load_dword v247, v246, s[48:51], 0 offen sc1
s_branch Lpoll_9
Lpolld_10:
s_mul_i32 s68, s62, 13440
s_add_u32 s68, s68, s60
s_waitcnt lgkmcnt(0)
buffer_atomic_add_f32 v136, v232, s[32:35], s68 offen offset:0
buffer_atomic_add_f32 v137, v232, s[32:35], s68 offen offset:256
buffer_atomic_add_f32 v138, v232, s[32:35], s68 offen offset:512
buffer_atomic_add_f32 v139, v232, s[32:35], s68 offen offset:768
buffer_atomic_add_f32 v140, v232, s[32:35], s68 offen offset:1024
buffer_atomic_add_f32 v141, v232, s[32:35], s68 offen offset:1280
buffer_atomic_add_f32 v142, v232, s[32:35], s68 offen offset:1536
buffer_atomic_add_f32 v143, v232, s[32:35], s68 offen offset:1792
buffer_atomic_add_f32 v144, v232, s[32:35], s68 offen offset:2048
buffer_atomic_add_f32 v145, v232, s[32:35], s68 offen offset:2304
buffer_atomic_add_f32 v146, v232, s[32:35], s68 offen offset:2560
buffer_atomic_add_f32 v147, v232, s[32:35], s68 offen offset:2816
buffer_atomic_add_f32 v148, v232, s[32:35], s68 offen offset:3072
s_mov_b64 exec, 0xff
buffer_atomic_add_f32 v149, v232, s[32:35], s68 offen offset:3328
s_mov_b64 exec, -1
s_branch Lp1_end
Lp1_epi_q:
v_and_b32 v232, 15, v1
v_lshlrev_b32 v232, 3, v232
s_lshl_b32 s60, s26, 8
v_add_u32 v232, s60, v232
ds_read_b64 v[230:231], v232 offset:10496
ds_read_b64 v[240:241], v232 offset:10624
v_lshrrev_b32 v233, 4, v1
v_lshlrev_b32 v234, 4, v233
ds_read_b128 v[170:173], v234 offset:9216
ds_read_b128 v[190:193], v234 offset:9536
ds_read_b128 v[174:177], v234 offset:9280
ds_read_b128 v[194:197], v234 offset:9600
ds_read_b128 v[178:181], v234 offset:9344
ds_read_b128 v[198:201], v234 offset:9664
ds_read_b128 v[182:185], v234 offset:9408
ds_read_b128 v[202:205], v234 offset:9728
ds_read_b128 v[186:189], v234 offset:9472
ds_read_b128 v[206:209], v234 offset:9792
s_waitcnt lgkmcnt(0)
v_pk_add_f32 v[170:171], v[170:171], v[190:191]
v_pk_add_f32 v[172:173], v[172:173], v[192:193]
v_pk_add_f32 v[174:175], v[174:175], v[194:195]
v_pk_add_f32 v[176:177], v[176:177], v[196:197]
v_pk_add_f32 v[178:179], v[178:179], v[198:199]
v_pk_add_f32 v[180:181], v[180:181], v[200:201]
v_pk_add_f32 v[182:183], v[182:183], v[202:203]
v_pk_add_f32 v[184:185], v[184:185], v[204:205]
v_pk_add_f32 v[186:187], v[186:187], v[206:207]
v_pk_add_f32 v[188:189], v[188:189], v[208:209]
v_and_b32 v232, 15, v1
v_lshrrev_b32 v233, 4, v1
v_mul_u32_u24 v233, 2560, v233
v_lshlrev_b32 v232, 4, v232
v_add_u32 v248, v232, v233
s_lshl_b32 s60, s61, 2
s_add_u32 s60, s60, s26
s_lshl_b32 s60, s60, 5
s_lshl_b32 s68, s62, 3
s_add_u32 s60, s60, s68
s_mul_i32 s60, s60, 2560
s_add_u32 s69, s60, 131072
v_pk_mul_f32 v[206:207], v[170:171], v[230:231] op_sel:[0,1] op_sel_hi:[1,1]
v_pk_fma_f32 v[20:21], v[20:21], v[230:231], v[206:207] op_sel_hi:[1,0,1]
v_pk_mul_f32 v[206:207], v[172:173], v[230:231] op_sel:[0,1] op_sel_hi:[1,1]
v_pk_fma_f32 v[22:23], v[22:23], v[230:231], v[206:207] op_sel_hi:[1,0,1]
v_pk_mul_f32 v[206:207], v[174:175], v[230:231] op_sel:[0,1] op_sel_hi:[1,1]
v_pk_fma_f32 v[24:25], v[24:25], v[230:231], v[206:207] op_sel_hi:[1,0,1]
v_pk_mul_f32 v[206:207], v[176:177], v[230:231] op_sel:[0,1] op_sel_hi:[1,1]
v_pk_fma_f32 v[26:27], v[26:27], v[230:231], v[206:207] op_sel_hi:[1,0,1]
v_pk_mul_f32 v[206:207], v[178:179], v[230:231] op_sel:[0,1] op_sel_hi:[1,1]
v_pk_fma_f32 v[28:29], v[28:29], v[230:231], v[206:207] op_sel_hi:[1,0,1]
v_pk_mul_f32 v[206:207], v[180:181], v[230:231] op_sel:[0,1] op_sel_hi:[1,1]
v_pk_fma_f32 v[30:31], v[30:31], v[230:231], v[206:207] op_sel_hi:[1,0,1]
v_pk_mul_f32 v[206:207], v[182:183], v[230:231] op_sel:[0,1] op_sel_hi:[1,1]
v_pk_fma_f32 v[32:33], v[32:33], v[230:231], v[206:207] op_sel_hi:[1,0,1]
v_pk_mul_f32 v[206:207], v[184:185], v[230:231] op_sel:[0,1] op_sel_hi:[1,1]
v_pk_fma_f32 v[34:35], v[34:35], v[230:231], v[206:207] op_sel_hi:[1,0,1]
v_pk_mul_f32 v[206:207], v[186:187], v[230:231] op_sel:[0,1] op_sel_hi:[1,1]
v_pk_fma_f32 v[36:37], v[36:37], v[230:231], v[206:207] op_sel_hi:[1,0,1]
v_pk_mul_f32 v[206:207], v[188:189], v[230:231] op_sel:[0,1] op_sel_hi:[1,1]
v_pk_fma_f32 v[38:39], v[38:39], v[230:231], v[206:207] op_sel_hi:[1,0,1]
v_cvt_pk_bf16_f32 v190, v20, v21
v_cvt_pk_bf16_f32 v191, v22, v23
v_cvt_pk_bf16_f32 v192, v24, v25
v_cvt_pk_bf16_f32 v193, v26, v27
v_cvt_pk_bf16_f32 v194, v28, v29
v_cvt_pk_bf16_f32 v195, v30, v31
v_cvt_pk_bf16_f32 v196, v32, v33
v_cvt_pk_bf16_f32 v197, v34, v35
v_cvt_pk_bf16_f32 v198, v36, v37
v_cvt_pk_bf16_f32 v199, v38, v39
s_nop 1
v_mfma_f32_16x16x32_bf16 v[100:103], v[120:123], v[190:193], 0
v_mfma_f32_16x16x32_bf16 v[104:107], v[130:133], v[190:193], 0
v_mfma_f32_16x16x32_bf16 v[108:111], v[140:143], v[190:193], 0
v_mfma_f32_16x16x32_bf16 v[112:115], v[150:153], v[190:193], 0
v_mfma_f32_16x16x32_bf16 v[116:119], v[160:163], v[190:193], 0
v_mfma_f32_16x16x32_bf16 v[100:103], v[124:127], v[194:197], v[100:103]
v_mfma_f32_16x16x32_bf16 v[104:107], v[134:137], v[194:197], v[104:107]
v_mfma_f32_16x16x32_bf16 v[108:111], v[144:147], v[194:197], v[108:111]
v_mfma_f32_16x16x32_bf16 v[112:115], v[154:157], v[194:197], v[112:115]
v_mfma_f32_16x16x32_bf16 v[116:119], v[164:167], v[194:197], v[116:119]
v_mfma_f32_16x16x16_bf16 v[100:103], v[128:129], v[198:199], v[100:103]
v_mfma_f32_16x16x16_bf16 v[104:107], v[138:139], v[198:199], v[104:107]
v_mfma_f32_16x16x16_bf16 v[108:111], v[148:149], v[198:199], v[108:111]
v_mfma_f32_16x16x16_bf16 v[112:115], v[158:159], v[198:199], v[112:115]
v_mfma_f32_16x16x16_bf16 v[116:119], v[168:169], v[198:199], v[116:119]
s_nop 7
v_max3_f32 v250, v100, v101, v102
v_min3_f32 v252, v100, v101, v102
v_max3_f32 v250, v250, v103, v104
v_min3_f32 v252, v252, v103, v104
v_max3_f32 v250, v250, v105, v106
v_min3_f32 v252, v252, v105, v106
v_max3_f32 v250, v250, v107, v108
v_min3_f32 v252, v252, v107, v108
v_max3_f32 v250, v250, v109, v110
v_min3_f32 v252, v252, v109, v110
v_max3_f32 v250, v250, v111, v112
v_min3_f32 v252, v252, v111, v112
v_max3_f32 v250, v250, v113, v114
v_min3_f32 v252, v252, v113, v114
v_max3_f32 v250, v250, v115, v116
v_min3_f32 v252, v252, v115, v116
v_max3_f32 v250, v250, v117, v118
v_min3_f32 v252, v252, v117, v118
v_max_f32 v250, v250, v119
v_min_f32 v252, v252, v119
v_mul_f32 v250, s65, v250
v_mul_f32 v252, s64, v252
v_pk_fma_f32 v[210:211], v[100:101], s[70:71], v[250:251] op_sel_hi:[1,1,0]
v_pk_fma_f32 v[100:101], v[100:101], s[70:71], v[252:253] op_sel_hi:[1,1,0] neg_lo:[1,0,0] neg_hi:[1,0,0]
v_pk_fma_f32 v[212:213], v[102:103], s[70:71], v[250:251] op_sel_hi:[1,1,0]
v_pk_fma_f32 v[102:103], v[102:103], s[70:71], v[252:253] op_sel_hi:[1,1,0] neg_lo:[1,0,0] neg_hi:[1,0,0]
v_pk_fma_f32 v[214:215], v[104:105], s[70:71], v[250:251] op_sel_hi:[1,1,0]
v_pk_fma_f32 v[104:105], v[104:105], s[70:71], v[252:253] op_sel_hi:[1,1,0] neg_lo:[1,0,0] neg_hi:[1,0,0]
v_pk_fma_f32 v[216:217], v[106:107], s[70:71], v[250:251] op_sel_hi:[1,1,0]
v_pk_fma_f32 v[106:107], v[106:107], s[70:71], v[252:253] op_sel_hi:[1,1,0] neg_lo:[1,0,0] neg_hi:[1,0,0]
v_pk_fma_f32 v[218:219], v[108:109], s[70:71], v[250:251] op_sel_hi:[1,1,0]
v_pk_fma_f32 v[108:109], v[108:109], s[70:71], v[252:253] op_sel_hi:[1,1,0] neg_lo:[1,0,0] neg_hi:[1,0,0]
v_pk_fma_f32 v[220:221], v[110:111], s[70:71], v[250:251] op_sel_hi:[1,1,0]
v_pk_fma_f32 v[110:111], v[110:111], s[70:71], v[252:253] op_sel_hi:[1,1,0] neg_lo:[1,0,0] neg_hi:[1,0,0]
v_pk_fma_f32 v[222:223], v[112:113], s[70:71], v[250:251] op_sel_hi:[1,1,0]
v_pk_fma_f32 v[112:113], v[112:113], s[70:71], v[252:253] op_sel_hi:[1,1,0] neg_lo:[1,0,0] neg_hi:[1,0,0]
v_pk_fma_f32 v[224:225], v[114:115], s[70:71], v[250:251] op_sel_hi:[1,1,0]
v_pk_fma_f32 v[114:115], v[114:115], s[70:71], v[252:253] op_sel_hi:[1,1,0] neg_lo:[1,0,0] neg_hi:[1,0,0]
v_pk_fma_f32 v[226:227], v[116:117], s[70:71], v[250:251] op_sel_hi:[1,1,0]
v_pk_fma_f32 v[116:117], v[116:117], s[70:71], v[252:253] op_sel_hi:[1,1,0] neg_lo:[1,0,0] neg_hi:[1,0,0]
v_pk_fma_f32 v[228:229], v[118:119], s[70:71], v[250:251] op_sel_hi:[1,1,0]
v_pk_fma_f32 v[118:119], v[118:119], s[70:71], v[252:253] op_sel_hi:[1,1,0] neg_lo:[1,0,0] neg_hi:[1,0,0]
v_exp_f32 v210, v210
v_exp_f32 v100, v100
v_exp_f32 v211, v211
v_exp_f32 v101, v101
v_exp_f32 v212, v212
v_exp_f32 v102, v102
v_exp_f32 v213, v213
v_exp_f32 v103, v103
v_exp_f32 v214, v214
v_exp_f32 v104, v104
v_exp_f32 v215, v215
v_exp_f32 v105, v105
v_exp_f32 v216, v216
v_exp_f32 v106, v106
v_exp_f32 v217, v217
v_exp_f32 v107, v107
v_exp_f32 v218, v218
v_exp_f32 v108, v108
v_exp_f32 v219, v219
v_exp_f32 v109, v109
v_exp_f32 v220, v220
v_exp_f32 v110, v110
v_exp_f32 v221, v221
v_exp_f32 v111, v111
v_exp_f32 v222, v222
v_exp_f32 v112, v112
v_exp_f32 v223, v223
v_exp_f32 v113, v113
v_exp_f32 v224, v224
v_exp_f32 v114, v114
v_exp_f32 v225, v225
v_exp_f32 v115, v115
v_exp_f32 v226, v226
v_exp_f32 v116, v116
v_exp_f32 v227, v227
v_exp_f32 v117, v117
v_exp_f32 v228, v228
v_exp_f32 v118, v118
v_exp_f32 v229, v229
v_exp_f32 v119, v119
s_nop 0
v_pk_add_f32 v[250:251], v[210:211], v[212:213]
v_pk_add_f32 v[252:253], v[100:101], v[102:103]
v_pk_add_f32 v[250:251], v[250:251], v[214:215]
v_pk_add_f32 v[252:253], v[252:253], v[104:105]
v_pk_add_f32 v[250:251], v[250:251], v[216:217]
v_pk_add_f32 v[252:253], v[252:253], v[106:107]
v_pk_add_f32 v[250:251], v[250:251], v[218:219]
v_pk_add_f32 v[252:253], v[252:253], v[108:109]
v_pk_add_f32 v[250:251], v[250:251], v[220:221]
v_pk_add_f32 v[252:253], v[252:253], v[110:111]
v_pk_add_f32 v[250:251], v[250:251], v[222:223]
v_pk_add_f32 v[252:253], v[252:253], v[112:113]
v_pk_add_f32 v[250:251], v[250:251], v[224:225]
v_pk_add_f32 v[252:253], v[252:253], v[114:115]
v_pk_add_f32 v[250:251], v[250:251], v[226:227]
v_pk_add_f32 v[252:253], v[252:253], v[116:117]
v_pk_add_f32 v[250:251], v[250:251], v[228:229]
v_pk_add_f32 v[252:253], v[252:253], v[118:119]
v_add_f32 v250, v250, v251
v_add_f32 v252, v252, v253
v_rcp_f32 v250, v250
v_rcp_f32 v252, v252
s_nop 0
v_pk_mul_f32 v[210:211], v[210:211], v[250:251] op_sel_hi:[1,0]
v_pk_mul_f32 v[100:101], v[100:101], v[252:253] op_sel_hi:[1,0]
v_pk_mul_f32 v[212:213], v[212:213], v[250:251] op_sel_hi:[1,0]
v_pk_mul_f32 v[102:103], v[102:103], v[252:253] op_sel_hi:[1,0]
v_pk_mul_f32 v[214:215], v[214:215], v[250:251] op_sel_hi:[1,0]
v_pk_mul_f32 v[104:105], v[104:105], v[252:253] op_sel_hi:[1,0]
v_pk_mul_f32 v[216:217], v[216:217], v[250:251] op_sel_hi:[1,0]
v_pk_mul_f32 v[106:107], v[106:107], v[252:253] op_sel_hi:[1,0]
v_pk_mul_f32 v[218:219], v[218:219], v[250:251] op_sel_hi:[1,0]
v_pk_mul_f32 v[108:109], v[108:109], v[252:253] op_sel_hi:[1,0]
v_pk_mul_f32 v[220:221], v[220:221], v[250:251] op_sel_hi:[1,0]
v_pk_mul_f32 v[110:111], v[110:111], v[252:253] op_sel_hi:[1,0]
v_pk_mul_f32 v[222:223], v[222:223], v[250:251] op_sel_hi:[1,0]
v_pk_mul_f32 v[112:113], v[112:113], v[252:253] op_sel_hi:[1,0]
v_pk_mul_f32 v[224:225], v[224:225], v[250:251] op_sel_hi:[1,0]
v_pk_mul_f32 v[114:115], v[114:115], v[252:253] op_sel_hi:[1,0]
v_pk_mul_f32 v[226:227], v[226:227], v[250:251] op_sel_hi:[1,0]
v_pk_mul_f32 v[116:117], v[116:117], v[252:253] op_sel_hi:[1,0]
v_pk_mul_f32 v[228:229], v[228:229], v[250:251] op_sel_hi:[1,0]
v_pk_mul_f32 v[118:119], v[118:119], v[252:253] op_sel_hi:[1,0]
v_cvt_pk_bf16_f32 v20, v210, v211
v_cvt_pk_bf16_f32 v30, v100, v101
v_cvt_pk_bf16_f32 v21, v212, v213
v_cvt_pk_bf16_f32 v31, v102, v103
v_cvt_pk_bf16_f32 v22, v214, v215
v_cvt_pk_bf16_f32 v32, v104, v105
v_cvt_pk_bf16_f32 v23, v216, v217
v_cvt_pk_bf16_f32 v33, v106, v107
v_cvt_pk_bf16_f32 v24, v218, v219
v_cvt_pk_bf16_f32 v34, v108, v109
v_cvt_pk_bf16_f32 v25, v220, v221
v_cvt_pk_bf16_f32 v35, v110, v111
v_cvt_pk_bf16_f32 v26, v222, v223
v_cvt_pk_bf16_f32 v36, v112, v113
v_cvt_pk_bf16_f32 v27, v224, v225
v_cvt_pk_bf16_f32 v37, v114, v115
v_cvt_pk_bf16_f32 v28, v226, v227
v_cvt_pk_bf16_f32 v38, v116, v117
v_cvt_pk_bf16_f32 v29, v228, v229
v_cvt_pk_bf16_f32 v39, v118, v119
buffer_store_dwordx4 v[20:23], v248, s[32:35], s69 offen offset:0 sc0 sc1
buffer_store_dwordx4 v[24:27], v248, s[32:35], s69 offen offset:512 sc0 sc1
buffer_store_dwordx4 v[28:31], v248, s[32:35], s69 offen offset:1024 sc0 sc1
buffer_store_dwordx4 v[32:35], v248, s[32:35], s69 offen offset:1536 sc0 sc1
buffer_store_dwordx4 v[36:39], v248, s[32:35], s69 offen offset:2048 sc0 sc1
v_pk_mul_f32 v[206:207], v[170:171], v[240:241] op_sel:[0,1] op_sel_hi:[1,1]
v_pk_fma_f32 v[60:61], v[60:61], v[240:241], v[206:207] op_sel_hi:[1,0,1]
v_pk_mul_f32 v[206:207], v[172:173], v[240:241] op_sel:[0,1] op_sel_hi:[1,1]
v_pk_fma_f32 v[62:63], v[62:63], v[240:241], v[206:207] op_sel_hi:[1,0,1]
v_pk_mul_f32 v[206:207], v[174:175], v[240:241] op_sel:[0,1] op_sel_hi:[1,1]
v_pk_fma_f32 v[64:65], v[64:65], v[240:241], v[206:207] op_sel_hi:[1,0,1]
v_pk_mul_f32 v[206:207], v[176:177], v[240:241] op_sel:[0,1] op_sel_hi:[1,1]
v_pk_fma_f32 v[66:67], v[66:67], v[240:241], v[206:207] op_sel_hi:[1,0,1]
v_pk_mul_f32 v[206:207], v[178:179], v[240:241] op_sel:[0,1] op_sel_hi:[1,1]
v_pk_fma_f32 v[68:69], v[68:69], v[240:241], v[206:207] op_sel_hi:[1,0,1]
v_pk_mul_f32 v[206:207], v[180:181], v[240:241] op_sel:[0,1] op_sel_hi:[1,1]
v_pk_fma_f32 v[70:71], v[70:71], v[240:241], v[206:207] op_sel_hi:[1,0,1]
v_pk_mul_f32 v[206:207], v[182:183], v[240:241] op_sel:[0,1] op_sel_hi:[1,1]
v_pk_fma_f32 v[72:73], v[72:73], v[240:241], v[206:207] op_sel_hi:[1,0,1]
v_pk_mul_f32 v[206:207], v[184:185], v[240:241] op_sel:[0,1] op_sel_hi:[1,1]
v_pk_fma_f32 v[74:75], v[74:75], v[240:241], v[206:207] op_sel_hi:[1,0,1]
v_pk_mul_f32 v[206:207], v[186:187], v[240:241] op_sel:[0,1] op_sel_hi:[1,1]
v_pk_fma_f32 v[76:77], v[76:77], v[240:241], v[206:207] op_sel_hi:[1,0,1]
v_pk_mul_f32 v[206:207], v[188:189], v[240:241] op_sel:[0,1] op_sel_hi:[1,1]
v_pk_fma_f32 v[78:79], v[78:79], v[240:241], v[206:207] op_sel_hi:[1,0,1]
v_cvt_pk_bf16_f32 v190, v60, v61
v_cvt_pk_bf16_f32 v191, v62, v63
v_cvt_pk_bf16_f32 v192, v64, v65
v_cvt_pk_bf16_f32 v193, v66, v67
v_cvt_pk_bf16_f32 v194, v68, v69
v_cvt_pk_bf16_f32 v195, v70, v71
v_cvt_pk_bf16_f32 v196, v72, v73
v_cvt_pk_bf16_f32 v197, v74, v75
v_cvt_pk_bf16_f32 v198, v76, v77
v_cvt_pk_bf16_f32 v199, v78, v79
s_nop 1
v_mfma_f32_16x16x32_bf16 v[100:103], v[120:123], v[190:193], 0
v_mfma_f32_16x16x32_bf16 v[104:107], v[130:133], v[190:193], 0
v_mfma_f32_16x16x32_bf16 v[108:111], v[140:143], v[190:193], 0
v_mfma_f32_16x16x32_bf16 v[112:115], v[150:153], v[190:193], 0
v_mfma_f32_16x16x32_bf16 v[116:119], v[160:163], v[190:193], 0
v_mfma_f32_16x16x32_bf16 v[100:103], v[124:127], v[194:197], v[100:103]
v_mfma_f32_16x16x32_bf16 v[104:107], v[134:137], v[194:197], v[104:107]
v_mfma_f32_16x16x32_bf16 v[108:111], v[144:147], v[194:197], v[108:111]
v_mfma_f32_16x16x32_bf16 v[112:115], v[154:157], v[194:197], v[112:115]
v_mfma_f32_16x16x32_bf16 v[116:119], v[164:167], v[194:197], v[116:119]
v_mfma_f32_16x16x16_bf16 v[100:103], v[128:129], v[198:199], v[100:103]
v_mfma_f32_16x16x16_bf16 v[104:107], v[138:139], v[198:199], v[104:107]
v_mfma_f32_16x16x16_bf16 v[108:111], v[148:149], v[198:199], v[108:111]
v_mfma_f32_16x16x16_bf16 v[112:115], v[158:159], v[198:199], v[112:115]
v_mfma_f32_16x16x16_bf16 v[116:119], v[168:169], v[198:199], v[116:119]
s_nop 7
v_max3_f32 v250, v100, v101, v102
v_min3_f32 v252, v100, v101, v102
v_max3_f32 v250, v250, v103, v104
v_min3_f32 v252, v252, v103, v104
v_max3_f32 v250, v250, v105, v106
v_min3_f32 v252, v252, v105, v106
v_max3_f32 v250, v250, v107, v108
v_min3_f32 v252, v252, v107, v108
v_max3_f32 v250, v250, v109, v110
v_min3_f32 v252, v252, v109, v110
v_max3_f32 v250, v250, v111, v112
v_min3_f32 v252, v252, v111, v112
v_max3_f32 v250, v250, v113, v114
v_min3_f32 v252, v252, v113, v114
v_max3_f32 v250, v250, v115, v116
v_min3_f32 v252, v252, v115, v116
v_max3_f32 v250, v250, v117, v118
v_min3_f32 v252, v252, v117, v118
v_max_f32 v250, v250, v119
v_min_f32 v252, v252, v119
v_mul_f32 v250, s65, v250
v_mul_f32 v252, s64, v252
v_pk_fma_f32 v[210:211], v[100:101], s[70:71], v[250:251] op_sel_hi:[1,1,0]
v_pk_fma_f32 v[100:101], v[100:101], s[70:71], v[252:253] op_sel_hi:[1,1,0] neg_lo:[1,0,0] neg_hi:[1,0,0]
v_pk_fma_f32 v[212:213], v[102:103], s[70:71], v[250:251] op_sel_hi:[1,1,0]
v_pk_fma_f32 v[102:103], v[102:103], s[70:71], v[252:253] op_sel_hi:[1,1,0] neg_lo:[1,0,0] neg_hi:[1,0,0]
v_pk_fma_f32 v[214:215], v[104:105], s[70:71], v[250:251] op_sel_hi:[1,1,0]
v_pk_fma_f32 v[104:105], v[104:105], s[70:71], v[252:253] op_sel_hi:[1,1,0] neg_lo:[1,0,0] neg_hi:[1,0,0]
v_pk_fma_f32 v[216:217], v[106:107], s[70:71], v[250:251] op_sel_hi:[1,1,0]
v_pk_fma_f32 v[106:107], v[106:107], s[70:71], v[252:253] op_sel_hi:[1,1,0] neg_lo:[1,0,0] neg_hi:[1,0,0]
v_pk_fma_f32 v[218:219], v[108:109], s[70:71], v[250:251] op_sel_hi:[1,1,0]
v_pk_fma_f32 v[108:109], v[108:109], s[70:71], v[252:253] op_sel_hi:[1,1,0] neg_lo:[1,0,0] neg_hi:[1,0,0]
v_pk_fma_f32 v[220:221], v[110:111], s[70:71], v[250:251] op_sel_hi:[1,1,0]
v_pk_fma_f32 v[110:111], v[110:111], s[70:71], v[252:253] op_sel_hi:[1,1,0] neg_lo:[1,0,0] neg_hi:[1,0,0]
v_pk_fma_f32 v[222:223], v[112:113], s[70:71], v[250:251] op_sel_hi:[1,1,0]
v_pk_fma_f32 v[112:113], v[112:113], s[70:71], v[252:253] op_sel_hi:[1,1,0] neg_lo:[1,0,0] neg_hi:[1,0,0]
v_pk_fma_f32 v[224:225], v[114:115], s[70:71], v[250:251] op_sel_hi:[1,1,0]
v_pk_fma_f32 v[114:115], v[114:115], s[70:71], v[252:253] op_sel_hi:[1,1,0] neg_lo:[1,0,0] neg_hi:[1,0,0]
v_pk_fma_f32 v[226:227], v[116:117], s[70:71], v[250:251] op_sel_hi:[1,1,0]
v_pk_fma_f32 v[116:117], v[116:117], s[70:71], v[252:253] op_sel_hi:[1,1,0] neg_lo:[1,0,0] neg_hi:[1,0,0]
v_pk_fma_f32 v[228:229], v[118:119], s[70:71], v[250:251] op_sel_hi:[1,1,0]
v_pk_fma_f32 v[118:119], v[118:119], s[70:71], v[252:253] op_sel_hi:[1,1,0] neg_lo:[1,0,0] neg_hi:[1,0,0]
v_exp_f32 v210, v210
v_exp_f32 v100, v100
v_exp_f32 v211, v211
v_exp_f32 v101, v101
v_exp_f32 v212, v212
v_exp_f32 v102, v102
v_exp_f32 v213, v213
v_exp_f32 v103, v103
v_exp_f32 v214, v214
v_exp_f32 v104, v104
v_exp_f32 v215, v215
v_exp_f32 v105, v105
v_exp_f32 v216, v216
v_exp_f32 v106, v106
v_exp_f32 v217, v217
v_exp_f32 v107, v107
v_exp_f32 v218, v218
v_exp_f32 v108, v108
v_exp_f32 v219, v219
v_exp_f32 v109, v109
v_exp_f32 v220, v220
v_exp_f32 v110, v110
v_exp_f32 v221, v221
v_exp_f32 v111, v111
v_exp_f32 v222, v222
v_exp_f32 v112, v112
v_exp_f32 v223, v223
v_exp_f32 v113, v113
v_exp_f32 v224, v224
v_exp_f32 v114, v114
v_exp_f32 v225, v225
v_exp_f32 v115, v115
v_exp_f32 v226, v226
v_exp_f32 v116, v116
v_exp_f32 v227, v227
v_exp_f32 v117, v117
v_exp_f32 v228, v228
v_exp_f32 v118, v118
v_exp_f32 v229, v229
v_exp_f32 v119, v119
s_nop 0
v_pk_add_f32 v[250:251], v[210:211], v[212:213]
v_pk_add_f32 v[252:253], v[100:101], v[102:103]
v_pk_add_f32 v[250:251], v[250:251], v[214:215]
v_pk_add_f32 v[252:253], v[252:253], v[104:105]
v_pk_add_f32 v[250:251], v[250:251], v[216:217]
v_pk_add_f32 v[252:253], v[252:253], v[106:107]
v_pk_add_f32 v[250:251], v[250:251], v[218:219]
v_pk_add_f32 v[252:253], v[252:253], v[108:109]
v_pk_add_f32 v[250:251], v[250:251], v[220:221]
v_pk_add_f32 v[252:253], v[252:253], v[110:111]
v_pk_add_f32 v[250:251], v[250:251], v[222:223]
v_pk_add_f32 v[252:253], v[252:253], v[112:113]
v_pk_add_f32 v[250:251], v[250:251], v[224:225]
v_pk_add_f32 v[252:253], v[252:253], v[114:115]
v_pk_add_f32 v[250:251], v[250:251], v[226:227]
v_pk_add_f32 v[252:253], v[252:253], v[116:117]
v_pk_add_f32 v[250:251], v[250:251], v[228:229]
v_pk_add_f32 v[252:253], v[252:253], v[118:119]
v_add_f32 v250, v250, v251
v_add_f32 v252, v252, v253
v_rcp_f32 v250, v250
v_rcp_f32 v252, v252
s_nop 0
v_pk_mul_f32 v[210:211], v[210:211], v[250:251] op_sel_hi:[1,0]
v_pk_mul_f32 v[100:101], v[100:101], v[252:253] op_sel_hi:[1,0]
v_pk_mul_f32 v[212:213], v[212:213], v[250:251] op_sel_hi:[1,0]
v_pk_mul_f32 v[102:103], v[102:103], v[252:253] op_sel_hi:[1,0]
v_pk_mul_f32 v[214:215], v[214:215], v[250:251] op_sel_hi:[1,0]
v_pk_mul_f32 v[104:105], v[104:105], v[252:253] op_sel_hi:[1,0]
v_pk_mul_f32 v[216:217], v[216:217], v[250:251] op_sel_hi:[1,0]
v_pk_mul_f32 v[106:107], v[106:107], v[252:253] op_sel_hi:[1,0]
v_pk_mul_f32 v[218:219], v[218:219], v[250:251] op_sel_hi:[1,0]
v_pk_mul_f32 v[108:109], v[108:109], v[252:253] op_sel_hi:[1,0]
v_pk_mul_f32 v[220:221], v[220:221], v[250:251] op_sel_hi:[1,0]
v_pk_mul_f32 v[110:111], v[110:111], v[252:253] op_sel_hi:[1,0]
v_pk_mul_f32 v[222:223], v[222:223], v[250:251] op_sel_hi:[1,0]
v_pk_mul_f32 v[112:113], v[112:113], v[252:253] op_sel_hi:[1,0]
v_pk_mul_f32 v[224:225], v[224:225], v[250:251] op_sel_hi:[1,0]
v_pk_mul_f32 v[114:115], v[114:115], v[252:253] op_sel_hi:[1,0]
v_pk_mul_f32 v[226:227], v[226:227], v[250:251] op_sel_hi:[1,0]
v_pk_mul_f32 v[116:117], v[116:117], v[252:253] op_sel_hi:[1,0]
v_pk_mul_f32 v[228:229], v[228:229], v[250:251] op_sel_hi:[1,0]
v_pk_mul_f32 v[118:119], v[118:119], v[252:253] op_sel_hi:[1,0]
v_cvt_pk_bf16_f32 v60, v210, v211
v_cvt_pk_bf16_f32 v70, v100, v101
v_cvt_pk_bf16_f32 v61, v212, v213
v_cvt_pk_bf16_f32 v71, v102, v103
v_cvt_pk_bf16_f32 v62, v214, v215
v_cvt_pk_bf16_f32 v72, v104, v105
v_cvt_pk_bf16_f32 v63, v216, v217
v_cvt_pk_bf16_f32 v73, v106, v107
v_cvt_pk_bf16_f32 v64, v218, v219
v_cvt_pk_bf16_f32 v74, v108, v109
v_cvt_pk_bf16_f32 v65, v220, v221
v_cvt_pk_bf16_f32 v75, v110, v111
v_cvt_pk_bf16_f32 v66, v222, v223
v_cvt_pk_bf16_f32 v76, v112, v113
v_cvt_pk_bf16_f32 v67, v224, v225
v_cvt_pk_bf16_f32 v77, v114, v115
v_cvt_pk_bf16_f32 v68, v226, v227
v_cvt_pk_bf16_f32 v78, v116, v117
v_cvt_pk_bf16_f32 v69, v228, v229
v_cvt_pk_bf16_f32 v79, v118, v119
buffer_store_dwordx4 v[60:63], v248, s[32:35], s69 offen offset:256 sc0 sc1
buffer_store_dwordx4 v[64:67], v248, s[32:35], s69 offen offset:768 sc0 sc1
buffer_store_dwordx4 v[68:71], v248, s[32:35], s69 offen offset:1280 sc0 sc1
buffer_store_dwordx4 v[72:75], v248, s[32:35], s69 offen offset:1792 sc0 sc1
buffer_store_dwordx4 v[76:79], v248, s[32:35], s69 offen offset:2304 sc0 sc1
s_branch Lp1_end
Lp1_pack:
s_mov_b32 s36, s4
s_mov_b32 s37, s5
s_mov_b32 s38, 0x280000
s_mov_b32 s39, 0x00020000
s_mov_b32 s40, s6
s_mov_b32 s41, s7
s_mov_b32 s42, 0x258000
s_mov_b32 s43, 0x00020000
s_sub_u32 s52, s28, 24
s_lshr_b32 s66, s27, 1
s_mul_i32 s66, s66, 655360
s_mul_i32 s60, s52, 640
s_add_u32 s60, s60, 0
v_add_u32 v232, s60, v0
v_lshlrev_b32 v232, 7, v232
buffer_load_dword v250, v232, s[36:39], s66 offen
s_mul_i32 s60, s52, 640
s_add_u32 s60, s60, 512
v_add_u32 v232, s60, v0
v_lshlrev_b32 v232, 7, v232
v_cmp_gt_u32 vcc, 128, v0
s_and_saveexec_b64 s[68:69], vcc
buffer_load_dword v251, v232, s[36:39], s66 offen
s_mov_b64 exec, s[68:69]
s_and_b32 s66, s27, 1
s_mul_i32 s66, s66, 640
s_mul_i32 s60, s52, 1200
s_add_u32 s60, s60, 0
v_add_u32 v232, s60, v0
v_mul_u32_u24 v233, 17477, v232
v_lshrrev_b32 v233, 18, v233
v_mul_u32_u24 v234, 15, v233
v_sub_u32 v234, v232, v234
v_mul_u32_u24 v235, 205, v234
v_lshrrev_b32 v235, 10, v235
v_mul_u32_u24 v236, 5, v235
v_sub_u32 v236, v234, v236
v_mul_u32_u24 v233, 3840, v233
v_mul_u32_u24 v235, 1280, v235
v_lshlrev_b32 v236, 7, v236
v_add3_u32 v233, v233, v235, v236
buffer_load_dword v252, v233, s[40:43], s66 offen
s_mul_i32 s60, s52, 1200
s_add_u32 s60, s60, 512
v_add_u32 v232, s60, v0
v_mul_u32_u24 v233, 17477, v232
v_lshrrev_b32 v233, 18, v233
v_mul_u32_u24 v234, 15, v233
v_sub_u32 v234, v232, v234
v_mul_u32_u24 v235, 205, v234
v_lshrrev_b32 v235, 10, v235
v_mul_u32_u24 v236, 5, v235
v_sub_u32 v236, v234, v236
v_mul_u32_u24 v233, 3840, v233
v_mul_u32_u24 v235, 1280, v235
v_lshlrev_b32 v236, 7, v236
v_add3_u32 v233, v233, v235, v236
buffer_load_dword v253, v233, s[40:43], s66 offen
s_mul_i32 s60, s52, 1200
s_add_u32 s60, s60, 1024
v_add_u32 v232, s60, v0
v_mul_u32_u24 v233, 17477, v232
v_lshrrev_b32 v233, 18, v233
v_mul_u32_u24 v234, 15, v233
v_sub_u32 v234, v232, v234
v_mul_u32_u24 v235, 205, v234
v_lshrrev_b32 v235, 10, v235
v_mul_u32_u24 v236, 5, v235
v_sub_u32 v236, v234, v236
v_mul_u32_u24 v233, 3840, v233
v_mul_u32_u24 v235, 1280, v235
v_lshlrev_b32 v236, 7, v236
v_add3_u32 v233, v233, v235, v236
v_cmp_gt_u32 vcc, 176, v0
s_and_saveexec_b64 s[68:69], vcc
buffer_load_dword v254, v233, s[40:43], s66 offen
s_mov_b64 exec, s[68:69]
s_getpc_b64 s[70:71]
Lpc_11:
s_sub_u32 s70, s70, Lpc_11-p1_kernel
s_subb_u32 s71, s71, 0
v_lshlrev_b32 v232, 7, v0
v_min_u32 v232, Lcode_end-p1_kernel-4, v232
global_load_dword v255, v232, s[70:71]
s_waitcnt vmcnt(0)
s_sub_u32 s52, s28, 24
s_lshl_b32 s52, s52, 3
s_add_u32 s52, s52, s27
s_cmp_ge_u32 s52, 57
s_cbranch_scc1 Lp1_end
s_cmp_ge_u32 s26, 4
s_cbranch_scc1 Lp1_exit
v_and_b32 v1, 63, v0
v_lshlrev_b32 v2, 4, v1
v_lshrrev_b32 v3, 3, v1
v_and_b32 v4, 7, v1
v_lshlrev_b32 v4, 4, v4
v_lshrrev_b32 v5, 4, v1
v_bfe_u32 v6, v1, 2, 2
v_and_b32 v7, 3, v1
s_cmp_lt_u32 s52, 27
s_cbranch_scc0 Lp1_pack_not_gu
s_mov_b32 s36, s14
s_mov_b32 s37, s15
s_mov_b32 s38, 0x21c000
s_mov_b32 s39, 0x00020000
s_mov_b32 s40, s16
s_mov_b32 s41, s17
s_mov_b32 s42, 0x21c000
s_mov_b32 s43, 0x00020000
v_mul_u32_u24 v8, 3456, v3
v_add_u32 v8, v8, v4
s_mul_i32 s53, s26, 552960
s_lshl_b32 s54, s52, 7
s_add_u32 s53, s53, s54
s_mov_b32 s55, s53
s_mul_i32 s56, s26, 20480
s_add_u32 s57, s56, 81920
s_mov_b32 s60, 20
Lpdma_12:
s_mov_b32 m0, s56
s_add_u32 s56, s56, 1024
buffer_load_dwordx4 v8, s[36:39], s53 offen lds
s_add_u32 s53, s53, 27648
s_sub_u32 s60, s60, 1
s_cmp_lg_u32 s60, 0
s_cbranch_scc1 Lpdma_12
s_mov_b32 s60, 20
Lpdma_13:
s_mov_b32 m0, s57
s_add_u32 s57, s57, 1024
buffer_load_dwordx4 v8, s[40:43], s55 offen lds
s_add_u32 s55, s55, 27648
s_sub_u32 s60, s60, 1
s_cmp_lg_u32 s60, 0
s_cbranch_scc1 Lpdma_13
v_and_b32 v9, 1, v5
v_mul_u32_u24 v9, 81920, v9
v_lshrrev_b32 v10, 1, v5
v_lshlrev_b32 v10, 3, v10
v_add_u32 v10, v10, v6
v_lshlrev_b32 v10, 7, v10
v_add_u32 v9, v9, v10
v_and_b32 v10, 1, v7
v_lshlrev_b32 v10, 4, v10
v_add_u32 v9, v9, v10
v_lshrrev_b32 v10, 1, v7
v_lshlrev_b32 v10, 3, v10
v_add_u32 v9, v9, v10
s_lshl_b32 s53, s26, 5
v_add_u32 v9, s53, v9
v_mov_b32 v12, 0x3f803f80
v_mov_b32 v13, 0x3f803f80
v_mov_b32 v14, 0x3f803f80
v_mov_b32 v15, 0x3f803f80
v_mov_b32 v16, 0
v_mov_b32 v17, 0
v_mov_b32 v18, 0
v_mov_b32 v19, 0
v_mov_b32 v20, 0
v_mov_b32 v21, 0
v_mov_b32 v22, 0
v_mov_b32 v23, 0
v_mov_b32 v24, 0
v_mov_b32 v25, 0
v_mov_b32 v26, 0
v_mov_b32 v27, 0
v_mov_b32 v28, 0
v_mov_b32 v29, 0
v_mov_b32 v30, 0
v_mov_b32 v31, 0
s_lshl_b32 s53, s52, 2
s_add_u32 s53, s53, s26
s_mul_i32 s53, s53, 41984
s_add_u32 s53, s53, 6225920
s_waitcnt vmcnt(0)
s_barrier
s_mov_b32 s60, 10
Lgu_14:
ds_read_b64_tr_b16 v[32:33], v9 offset:0
ds_read_b64_tr_b16 v[34:35], v9 offset:512
ds_read_b64_tr_b16 v[36:37], v9 offset:2048
ds_read_b64_tr_b16 v[38:39], v9 offset:2560
ds_read_b64_tr_b16 v[40:41], v9 offset:4096
ds_read_b64_tr_b16 v[42:43], v9 offset:4608
ds_read_b64_tr_b16 v[44:45], v9 offset:6144
ds_read_b64_tr_b16 v[46:47], v9 offset:6656
v_add_u32 v9, 8192, v9
s_waitcnt lgkmcnt(6)
v_mfma_f32_32x32x16_bf16 v[16:31], v[12:15], v[32:35], v[16:31]
buffer_store_dwordx4 v[32:35], v2, s[32:35], s53 offen sc0 sc1
s_add_u32 s53, s53, 1024
s_waitcnt lgkmcnt(4)
v_mfma_f32_32x32x16_bf16 v[16:31], v[12:15], v[36:39], v[16:31]
buffer_store_dwordx4 v[36:39], v2, s[32:35], s53 offen sc0 sc1
s_add_u32 s53, s53, 1024
s_waitcnt lgkmcnt(2)
v_mfma_f32_32x32x16_bf16 v[16:31], v[12:15], v[40:43], v[16:31]
buffer_store_dwordx4 v[40:43], v2, s[32:35], s53 offen sc0 sc1
s_add_u32 s53, s53, 1024
s_waitcnt lgkmcnt(0)
v_mfma_f32_32x32x16_bf16 v[16:31], v[12:15], v[44:47], v[16:31]
buffer_store_dwordx4 v[44:47], v2, s[32:35], s53 offen sc0 sc1
s_add_u32 s53, s53, 1024
s_sub_u32 s60, s60, 1
s_cmp_lg_u32 s60, 0
s_cbranch_scc1 Lgu_14
s_nop 13
v_cvt_pk_bf16_f32 v32, v16, v16
v_lshlrev_b32 v33, 16, v32
v_sub_f32 v34, v16, v33
v_cvt_pk_bf16_f32 v36, v33, v34
v_cmp_gt_u32 vcc, 32, v1
s_nop 1
v_cndmask_b32 v36, 0, v36, vcc
v_mov_b32 v37, v36
v_mov_b32 v38, 0
v_mov_b32 v39, 0
buffer_store_dwordx4 v[36:39], v2, s[32:35], s53 offen sc0 sc1
s_branch Lp1_end
Lp1_pack_not_gu:
s_cmp_lt_u32 s52, 47
s_cbranch_scc0 Lp1_pack_wo
s_mov_b32 s36, s18
s_mov_b32 s37, s19
s_mov_b32 s38, 0x21c000
s_mov_b32 s39, 0x00020000
s_sub_u32 s52, s52, 27
s_lshr_b32 s58, s52, 1
s_and_b32 s59, s52, 1
v_mul_u32_u24 v8, 1280, v3
v_add_u32 v8, v8, v4
s_mul_i32 s53, s59, 1105920
s_mul_i32 s54, s26, 276480
s_add_u32 s53, s53, s54
s_lshl_b32 s54, s58, 7
s_add_u32 s53, s53, s54
s_mul_i32 s56, s26, 27648
s_mov_b32 s60, 27
Lpdma_15:
s_mov_b32 m0, s56
s_add_u32 s56, s56, 1024
buffer_load_dwordx4 v8, s[36:39], s53 offen lds
s_add_u32 s53, s53, 10240
s_sub_u32 s60, s60, 1
s_cmp_lg_u32 s60, 0
s_cbranch_scc1 Lpdma_15
v_lshlrev_b32 v9, 3, v5
v_add_u32 v9, v9, v6
v_lshlrev_b32 v9, 7, v9
v_lshlrev_b32 v10, 3, v7
v_add_u32 v9, v9, v10
s_lshl_b32 s53, s26, 5
v_add_u32 v9, s53, v9
s_lshl_b32 s53, s58, 2
s_add_u32 s53, s53, s26
s_mul_i32 s54, s53, 52429
s_lshr_b32 s54, s54, 18
s_mul_i32 s55, s54, 5
s_sub_u32 s55, s53, s55
s_mul_i32 s54, s54, 54
s_mul_i32 s56, s59, 27
s_add_u32 s54, s54, s56
s_mul_i32 s54, s54, 5
s_add_u32 s54, s54, s55
s_lshl_b32 s53, s54, 10
s_add_u32 s53, s53, 10813440
s_waitcnt vmcnt(0)
s_barrier
s_mov_b32 s60, 9
Lwd_16:
ds_read_b64_tr_b16 v[32:33], v9 offset:0
ds_read_b64_tr_b16 v[34:35], v9 offset:512
ds_read_b64_tr_b16 v[36:37], v9 offset:4096
ds_read_b64_tr_b16 v[38:39], v9 offset:4608
ds_read_b64_tr_b16 v[40:41], v9 offset:8192
ds_read_b64_tr_b16 v[42:43], v9 offset:8704
v_add_u32 v9, 12288, v9
s_waitcnt lgkmcnt(4)
buffer_store_dwordx4 v[32:35], v2, s[32:35], s53 offen sc0 sc1
s_add_u32 s53, s53, 5120
s_waitcnt lgkmcnt(2)
buffer_store_dwordx4 v[36:39], v2, s[32:35], s53 offen sc0 sc1
s_add_u32 s53, s53, 5120
s_waitcnt lgkmcnt(0)
buffer_store_dwordx4 v[40:43], v2, s[32:35], s53 offen sc0 sc1
s_add_u32 s53, s53, 5120
s_sub_u32 s60, s60, 1
s_cmp_lg_u32 s60, 0
s_cbranch_scc1 Lwd_16
s_branch Lp1_end
Lp1_pack_wo:
s_mov_b32 s36, s10
s_mov_b32 s37, s11
s_mov_b32 s38, 0xc8000
s_mov_b32 s39, 0x00020000
s_sub_u32 s58, s52, 47
v_mul_u32_u24 v8, 1280, v3
v_add_u32 v8, v8, v4
s_mul_i32 s53, s26, 204800
s_lshl_b32 s54, s58, 7
s_add_u32 s53, s53, s54
s_mul_i32 s56, s26, 20480
s_mov_b32 s60, 20
Lpdma_17:
s_mov_b32 m0, s56
s_add_u32 s56, s56, 1024
buffer_load_dwordx4 v8, s[36:39], s53 offen lds
s_add_u32 s53, s53, 10240
s_sub_u32 s60, s60, 1
s_cmp_lg_u32 s60, 0
s_cbranch_scc1 Lpdma_17
s_and_b32 s53, s26, 1
s_lshl_b32 s53, s53, 6
s_lshr_b32 s54, s26, 1
s_mul_i32 s55, s54, 40960
s_add_u32 s53, s53, s55
s_lshl_b32 s54, s54, 4
v_and_b32 v10, 1, v5
v_lshlrev_b32 v10, 4, v10
v_lshlrev_b32 v11, 2, v7
v_add_u32 v10, v10, v11
v_add_u32 v10, s54, v10
v_lshrrev_b32 v11, 1, v5
v_lshlrev_b32 v12, 2, v11
v_add_u32 v12, v12, v6
v_lshlrev_b32 v12, 7, v12
v_mul_u32_u24 v13, 20, v11
v_add_u32 v13, v13, v6
v_add_u32 v13, 16, v13
v_lshlrev_b32 v13, 7, v13
v_add_u32 v14, 0, v10
v_and_b32 v14, 31, v14
v_lshlrev_b32 v14, 1, v14
v_add_u32 v14, s53, v14
v_add_u32 v16, v12, v14
v_add_u32 v18, v13, v14
v_add_u32 v14, 8, v10
v_and_b32 v14, 31, v14
v_lshlrev_b32 v14, 1, v14
v_add_u32 v14, s53, v14
v_add_u32 v17, v12, v14
v_add_u32 v19, v13, v14
s_lshl_b32 s53, s58, 1
s_and_b32 s54, s26, 1
s_add_u32 s53, s53, s54
s_mul_i32 s54, s53, 52429
s_lshr_b32 s54, s54, 18
s_mul_i32 s55, s54, 5
s_sub_u32 s55, s53, s55
s_lshl_b32 s54, s54, 3
s_lshr_b32 s56, s26, 1
s_lshl_b32 s56, s56, 2
s_add_u32 s54, s54, s56
s_mul_i32 s54, s54, 25
s_add_u32 s54, s54, s55
s_lshl_b32 s53, s54, 10
s_add_u32 s53, s53, 5373952
s_waitcnt vmcnt(0)
s_barrier
ds_read_b64_tr_b16 v[32:33], v16 offset:0
ds_read_b64_tr_b16 v[34:35], v16 offset:1024
ds_read_b64_tr_b16 v[36:37], v16 offset:2560
ds_read_b64_tr_b16 v[38:39], v16 offset:3584
ds_read_b64_tr_b16 v[40:41], v16 offset:5120
ds_read_b64_tr_b16 v[42:43], v16 offset:6144
ds_read_b64_tr_b16 v[44:45], v16 offset:7680
ds_read_b64_tr_b16 v[46:47], v16 offset:8704
ds_read_b64_tr_b16 v[48:49], v18 offset:0
ds_read_b64_tr_b16 v[50:51], v18 offset:5120
s_waitcnt lgkmcnt(8)
buffer_store_dwordx4 v[32:35], v2, s[32:35], s53 offen sc0 sc1
s_add_u32 s53, s53, 5120
s_waitcnt lgkmcnt(6)
buffer_store_dwordx4 v[36:39], v2, s[32:35], s53 offen sc0 sc1
s_add_u32 s53, s53, 5120
s_waitcnt lgkmcnt(4)
buffer_store_dwordx4 v[40:43], v2, s[32:35], s53 offen sc0 sc1
s_add_u32 s53, s53, 5120
s_waitcnt lgkmcnt(2)
buffer_store_dwordx4 v[44:47], v2, s[32:35], s53 offen sc0 sc1
s_add_u32 s53, s53, 5120
s_waitcnt lgkmcnt(0)
buffer_store_dwordx4 v[48:51], v2, s[32:35], s53 offen sc0 sc1
s_add_u32 s53, s53, 5120
s_nop 1
ds_read_b64_tr_b16 v[32:33], v16 offset:10240
ds_read_b64_tr_b16 v[34:35], v16 offset:11264
ds_read_b64_tr_b16 v[36:37], v16 offset:12800
ds_read_b64_tr_b16 v[38:39], v16 offset:13824
ds_read_b64_tr_b16 v[40:41], v16 offset:15360
ds_read_b64_tr_b16 v[42:43], v16 offset:16384
ds_read_b64_tr_b16 v[44:45], v16 offset:17920
ds_read_b64_tr_b16 v[46:47], v16 offset:18944
ds_read_b64_tr_b16 v[48:49], v18 offset:10240
ds_read_b64_tr_b16 v[50:51], v18 offset:15360
s_waitcnt lgkmcnt(8)
buffer_store_dwordx4 v[32:35], v2, s[32:35], s53 offen sc0 sc1
s_add_u32 s53, s53, 5120
s_waitcnt lgkmcnt(6)
buffer_store_dwordx4 v[36:39], v2, s[32:35], s53 offen sc0 sc1
s_add_u32 s53, s53, 5120
s_waitcnt lgkmcnt(4)
buffer_store_dwordx4 v[40:43], v2, s[32:35], s53 offen sc0 sc1
s_add_u32 s53, s53, 5120
s_waitcnt lgkmcnt(2)
buffer_store_dwordx4 v[44:47], v2, s[32:35], s53 offen sc0 sc1
s_add_u32 s53, s53, 5120
s_waitcnt lgkmcnt(0)
buffer_store_dwordx4 v[48:51], v2, s[32:35], s53 offen sc0 sc1
s_add_u32 s53, s53, 5120
s_nop 1
ds_read_b64_tr_b16 v[32:33], v17 offset:20480
ds_read_b64_tr_b16 v[34:35], v17 offset:21504
ds_read_b64_tr_b16 v[36:37], v17 offset:23040
ds_read_b64_tr_b16 v[38:39], v17 offset:24064
ds_read_b64_tr_b16 v[40:41], v17 offset:25600
ds_read_b64_tr_b16 v[42:43], v17 offset:26624
ds_read_b64_tr_b16 v[44:45], v17 offset:28160
ds_read_b64_tr_b16 v[46:47], v17 offset:29184
ds_read_b64_tr_b16 v[48:49], v19 offset:20480
ds_read_b64_tr_b16 v[50:51], v19 offset:25600
s_waitcnt lgkmcnt(8)
buffer_store_dwordx4 v[32:35], v2, s[32:35], s53 offen sc0 sc1
s_add_u32 s53, s53, 5120
s_waitcnt lgkmcnt(6)
buffer_store_dwordx4 v[36:39], v2, s[32:35], s53 offen sc0 sc1
s_add_u32 s53, s53, 5120
s_waitcnt lgkmcnt(4)
buffer_store_dwordx4 v[40:43], v2, s[32:35], s53 offen sc0 sc1
s_add_u32 s53, s53, 5120
s_waitcnt lgkmcnt(2)
buffer_store_dwordx4 v[44:47], v2, s[32:35], s53 offen sc0 sc1
s_add_u32 s53, s53, 5120
s_waitcnt lgkmcnt(0)
buffer_store_dwordx4 v[48:51], v2, s[32:35], s53 offen sc0 sc1
s_add_u32 s53, s53, 5120
s_nop 1
ds_read_b64_tr_b16 v[32:33], v17 offset:30720
ds_read_b64_tr_b16 v[34:35], v17 offset:31744
ds_read_b64_tr_b16 v[36:37], v17 offset:33280
ds_read_b64_tr_b16 v[38:39], v17 offset:34304
ds_read_b64_tr_b16 v[40:41], v17 offset:35840
ds_read_b64_tr_b16 v[42:43], v17 offset:36864
ds_read_b64_tr_b16 v[44:45], v17 offset:38400
ds_read_b64_tr_b16 v[46:47], v17 offset:39424
ds_read_b64_tr_b16 v[48:49], v19 offset:30720
ds_read_b64_tr_b16 v[50:51], v19 offset:35840
s_waitcnt lgkmcnt(8)
buffer_store_dwordx4 v[32:35], v2, s[32:35], s53 offen sc0 sc1
s_add_u32 s53, s53, 5120
s_waitcnt lgkmcnt(6)
buffer_store_dwordx4 v[36:39], v2, s[32:35], s53 offen sc0 sc1
s_add_u32 s53, s53, 5120
s_waitcnt lgkmcnt(4)
buffer_store_dwordx4 v[40:43], v2, s[32:35], s53 offen sc0 sc1
s_add_u32 s53, s53, 5120
s_waitcnt lgkmcnt(2)
buffer_store_dwordx4 v[44:47], v2, s[32:35], s53 offen sc0 sc1
s_add_u32 s53, s53, 5120
s_waitcnt lgkmcnt(0)
buffer_store_dwordx4 v[48:51], v2, s[32:35], s53 offen sc0 sc1
s_add_u32 s53, s53, 5120
s_nop 1
s_branch Lp1_end
Lp1_end:
Lp1_exit:
s_endpgm
.globl p2_kernel
.p2align 8
.type p2_kernel,@function
p2_kernel:
s_cmp_ge_u32 s2, 256
s_cbranch_scc1 Lp2_exit
s_load_dwordx2 s[4:5], s[0:1], 0
s_load_dwordx2 s[24:25], s[0:1], 80
v_lshrrev_b32 v1, 6, v0
s_and_b32 s27, s2, 7
s_lshr_b32 s28, s2, 3
v_readfirstlane_b32 s26, v1
s_lshl_b32 s29, s27, 3
s_lshr_b32 s31, s28, 2
s_add_u32 s29, s29, s31
s_and_b32 s30, s28, 3
v_and_b32 v1, 63, v0
v_lshlrev_b32 v2, 4, v1
s_getpc_b64 s[70:71]
Lpc_18:
s_sub_u32 s70, s70, Lpc_18-p2_kernel
s_subb_u32 s71, s71, 0
v_lshlrev_b32 v3, 7, v1
v_min_u32 v3, Lp2_exit-p2_kernel-4, v3
global_load_dword v255, v3, s[70:71]
s_waitcnt lgkmcnt(0)
s_mov_b32 s32, s24
s_mov_b32 s33, s25
s_mov_b32 s34, 0x1600000
s_mov_b32 s35, 0x00020000
s_mov_b32 s36, s4
s_mov_b32 s37, s5
s_mov_b32 s38, 0x280000
s_mov_b32 s39, 0x00020000
s_mul_i32 s40, s26, 26880
s_mul_i32 s41, s26, 27648
s_lshl_b32 s42, s29, 5
s_lshl_b32 s43, s26, 3
s_add_u32 s42, s42, s43
s_mul_i32 s42, s42, 2560
s_add_u32 s42, s42, 131072
v_and_b32 v3, 31, v1
v_lshlrev_b32 v11, 4, v3
s_add_u32 m0, s41, 0
s_nop 0
buffer_load_dwordx4 v2, s[32:35], s40 offen offset:0 lds
s_add_u32 m0, s41, 0
s_nop 0
buffer_load_dwordx4 v2, s[32:35], s40 offen offset:1024 lds
s_add_u32 m0, s41, 0
s_nop 0
buffer_load_dwordx4 v2, s[32:35], s40 offen offset:2048 lds
s_add_u32 m0, s41, 0
s_nop 0
buffer_load_dwordx4 v2, s[32:35], s40 offen offset:3072 lds
s_add_u32 s40, s40, 4096
buffer_load_dwordx4 a[0:3], v2, s[32:35], s42 offen
buffer_load_dwordx4 a[4:7], v2, s[32:35], s42 offen offset:1024
buffer_load_dwordx4 a[8:11], v11, s[32:35], s42 offen offset:2048
s_add_u32 s42, s42, 2560
s_add_u32 m0, s41, 4096
s_nop 0
buffer_load_dwordx4 v2, s[32:35], s40 offen offset:0 lds
s_add_u32 m0, s41, 4096
s_nop 0
buffer_load_dwordx4 v2, s[32:35], s40 offen offset:1024 lds
s_add_u32 m0, s41, 4096
s_nop 0
buffer_load_dwordx4 v2, s[32:35], s40 offen offset:2048 lds
buffer_load_dwordx4 a[12:15], v2, s[32:35], s42 offen
buffer_load_dwordx4 a[16:19], v2, s[32:35], s42 offen offset:1024
buffer_load_dwordx4 a[20:23], v11, s[32:35], s42 offen offset:2048
s_add_u32 s42, s42, 2560
s_add_u32 m0, s41, 4096
s_nop 0
buffer_load_dwordx4 v2, s[32:35], s40 offen offset:3072 lds
s_add_u32 s40, s40, 4096
s_add_u32 m0, s41, 8192
s_nop 0
buffer_load_dwordx4 v2, s[32:35], s40 offen offset:0 lds
s_add_u32 m0, s41, 8192
s_nop 0
buffer_load_dwordx4 v2, s[32:35], s40 offen offset:1024 lds
buffer_load_dwordx4 a[24:27], v2, s[32:35], s42 offen
buffer_load_dwordx4 a[28:31], v2, s[32:35], s42 offen offset:1024
buffer_load_dwordx4 a[32:35], v11, s[32:35], s42 offen offset:2048
s_add_u32 s42, s42, 2560
s_lshl_b32 s46, s30, 3
s_lshl_b32 s47, s26, 1
s_add_u32 s46, s46, s47
s_mul_i32 s46, s46, 25600
s_add_u32 s46, s46, 5373952
v_lshrrev_b32 v4, 5, v1
v_min_u32 v5, 20, v3
v_subrev_u32 v6, 4, v3
v_min_u32 v6, 20, v6
v_cmp_gt_u32 vcc, 16, v3
s_nop 0
v_cndmask_b32 v6, v6, v3, vcc
v_mul_u32_u24 v7, 336, v4
v_add_u32 v7, s41, v7
v_lshlrev_b32 v5, 4, v5
v_lshlrev_b32 v6, 4, v6
v_add_u32 v5, v5, v7
v_add_u32 v6, v6, v7
v_cmp_gt_u32 s[48:49], 32, v1
s_lshl_b32 s50, s26, 6
s_add_u32 s50, s50, 0
v_add_u32 v8, s50, v1
v_mul_u32_u24 v9, 3277, v8
v_lshrrev_b32 v9, 16, v9
v_mul_u32_u24 v10, 20, v9
v_sub_u32 v10, v8, v10
v_mul_u32_u24 v9, 1280, v9
v_lshlrev_b32 v10, 4, v10
v_add_u32 v9, v9, v10
s_mul_i32 s51, s29, 40960
s_mul_i32 s52, s30, 320
s_add_u32 s51, s51, s52
s_lshl_b32 s50, s50, 4
s_add_u32 m0, s50, 110592
s_nop 0
buffer_load_dwordx4 v9, s[36:39], s51 offen lds
Lxt_19:
s_lshl_b32 s50, s26, 6
s_add_u32 s50, s50, 256
v_add_u32 v8, s50, v1
v_mul_u32_u24 v9, 3277, v8
v_lshrrev_b32 v9, 16, v9
v_mul_u32_u24 v10, 20, v9
v_sub_u32 v10, v8, v10
v_mul_u32_u24 v9, 1280, v9
v_lshlrev_b32 v10, 4, v10
v_add_u32 v9, v9, v10
s_mul_i32 s51, s29, 40960
s_mul_i32 s52, s30, 320
s_add_u32 s51, s51, s52
s_lshl_b32 s50, s50, 4
s_add_u32 m0, s50, 110592
s_nop 0
buffer_load_dwordx4 v9, s[36:39], s51 offen lds
Lxt_20:
s_cmp_ge_u32 s26, 2
s_cbranch_scc1 Lxt_21
s_lshl_b32 s50, s26, 6
s_add_u32 s50, s50, 512
v_add_u32 v8, s50, v1
v_mul_u32_u24 v9, 3277, v8
v_lshrrev_b32 v9, 16, v9
v_mul_u32_u24 v10, 20, v9
v_sub_u32 v10, v8, v10
v_mul_u32_u24 v9, 1280, v9
v_lshlrev_b32 v10, 4, v10
v_add_u32 v9, v9, v10
s_mul_i32 s51, s29, 40960
s_mul_i32 s52, s30, 320
s_add_u32 s51, s51, s52
s_lshl_b32 s50, s50, 4
s_add_u32 m0, s50, 110592
s_nop 0
buffer_load_dwordx4 v9, s[36:39], s51 offen lds
Lxt_21:
v_mov_b32 v16, 0
v_mov_b32 v17, 0
v_mov_b32 v18, 0
v_mov_b32 v19, 0
v_mov_b32 v20, 0
v_mov_b32 v21, 0
v_mov_b32 v22, 0
v_mov_b32 v23, 0
v_mov_b32 v24, 0
v_mov_b32 v25, 0
v_mov_b32 v26, 0
v_mov_b32 v27, 0
v_mov_b32 v28, 0
v_mov_b32 v29, 0
v_mov_b32 v30, 0
v_mov_b32 v31, 0
v_mov_b32 v32, 0
v_mov_b32 v33, 0
v_mov_b32 v34, 0
v_mov_b32 v35, 0
v_mov_b32 v36, 0
v_mov_b32 v37, 0
v_mov_b32 v38, 0
v_mov_b32 v39, 0
v_mov_b32 v40, 0
v_mov_b32 v41, 0
v_mov_b32 v42, 0
v_mov_b32 v43, 0
v_mov_b32 v44, 0
v_mov_b32 v45, 0
v_mov_b32 v46, 0
v_mov_b32 v47, 0
v_mov_b32 v48, 0
v_mov_b32 v49, 0
v_mov_b32 v50, 0
v_mov_b32 v51, 0
v_mov_b32 v52, 0
v_mov_b32 v53, 0
v_mov_b32 v54, 0
v_mov_b32 v55, 0
v_mov_b32 v56, 0
v_mov_b32 v57, 0
v_mov_b32 v58, 0
v_mov_b32 v59, 0
v_mov_b32 v60, 0
v_mov_b32 v61, 0
v_mov_b32 v62, 0
v_mov_b32 v63, 0
v_mov_b32 v64, 0
v_mov_b32 v65, 0
v_mov_b32 v66, 0
v_mov_b32 v67, 0
v_mov_b32 v68, 0
v_mov_b32 v69, 0
v_mov_b32 v70, 0
v_mov_b32 v71, 0
v_mov_b32 v72, 0
v_mov_b32 v73, 0
v_mov_b32 v74, 0
v_mov_b32 v75, 0
v_mov_b32 v76, 0
v_mov_b32 v77, 0
v_mov_b32 v78, 0
v_mov_b32 v79, 0
v_mov_b32 v80, 0
v_mov_b32 v81, 0
v_mov_b32 v82, 0
v_mov_b32 v83, 0
v_mov_b32 v84, 0
v_mov_b32 v85, 0
v_mov_b32 v86, 0
v_mov_b32 v87, 0
v_mov_b32 v88, 0
v_mov_b32 v89, 0
v_mov_b32 v90, 0
v_mov_b32 v91, 0
v_mov_b32 v92, 0
v_mov_b32 v93, 0
v_mov_b32 v94, 0
v_mov_b32 v95, 0
s_add_u32 m0, s41, 8192
s_nop 0
buffer_load_dwordx4 v2, s[32:35], s40 offen offset:2048 lds
s_add_u32 m0, s41, 8192
s_nop 0
buffer_load_dwordx4 v2, s[32:35], s40 offen offset:3072 lds
s_add_u32 s40, s40, 4096
s_add_u32 m0, s41, 12288
s_nop 0
buffer_load_dwordx4 v2, s[32:35], s40 offen offset:0 lds
s_add_u32 m0, s41, 12288
s_nop 0
buffer_load_dwordx4 v2, s[32:35], s40 offen offset:1024 lds
buffer_load_dwordx4 a[36:39], v2, s[32:35], s42 offen
buffer_load_dwordx4 a[40:43], v2, s[32:35], s42 offen offset:1024
buffer_load_dwordx4 a[44:47], v11, s[32:35], s42 offen offset:2048
s_add_u32 s42, s42, 2560
buffer_load_dwordx4 a[96:99], v2, s[32:35], s46 offen offset:0
buffer_load_dwordx4 a[100:103], v2, s[32:35], s46 offen offset:1024
buffer_load_dwordx4 a[104:107], v2, s[32:35], s46 offen offset:2048
buffer_load_dwordx4 a[108:111], v2, s[32:35], s46 offen offset:3072
s_add_u32 s46, s46, 4096
s_waitcnt vmcnt(25)
ds_read_b128 v[112:115], v5 offset:0
ds_read_b128 v[116:119], v5 offset:672
ds_read_b128 v[120:123], v5 offset:1344
ds_read_b128 v[124:127], v5 offset:2016
ds_read_b128 v[128:131], v5 offset:2688
ds_read_b128 v[132:135], v5 offset:3024
s_waitcnt lgkmcnt(0)
v_cvt_pk_bf16_f32 v136, v112, v113
v_cvt_pk_bf16_f32 v137, v114, v115
v_cvt_pk_bf16_f32 v138, v116, v117
v_cvt_pk_bf16_f32 v139, v118, v119
v_cvt_pk_bf16_f32 v140, v120, v121
v_cvt_pk_bf16_f32 v141, v122, v123
v_cvt_pk_bf16_f32 v142, v124, v125
v_cvt_pk_bf16_f32 v143, v126, v127
v_cvt_pk_bf16_f32 v144, v128, v129
v_cvt_pk_bf16_f32 v145, v130, v131
v_cvt_pk_bf16_f32 v146, v132, v133
v_cvt_pk_bf16_f32 v147, v134, v135
v_cndmask_b32 v144, 0, v144, s[48:49]
v_cndmask_b32 v145, 0, v145, s[48:49]
v_cndmask_b32 v146, 0, v146, s[48:49]
v_cndmask_b32 v147, 0, v147, s[48:49]
s_nop 1
v_mfma_f32_32x32x16_bf16 v[96:111], v[136:139], a[0:3], 0
v_mfma_f32_32x32x16_bf16 v[96:111], v[140:143], a[4:7], v[96:111]
v_mfma_f32_32x32x16_bf16 v[96:111], v[144:147], a[8:11], v[96:111]
s_nop 12
v_add_f32 v188, 0x358637bd, v108
v_rcp_f32 v188, v188
s_nop 0
v_pk_mul_f32 v[96:97], v[96:97], v[188:189] op_sel_hi:[1,0]
v_pk_mul_f32 v[98:99], v[98:99], v[188:189] op_sel_hi:[1,0]
v_pk_mul_f32 v[100:101], v[100:101], v[188:189] op_sel_hi:[1,0]
v_pk_mul_f32 v[102:103], v[102:103], v[188:189] op_sel_hi:[1,0]
v_pk_mul_f32 v[104:105], v[104:105], v[188:189] op_sel_hi:[1,0]
v_pk_mul_f32 v[106:107], v[106:107], v[188:189] op_sel_hi:[1,0]
v_cvt_pk_bf16_f32 v148, v96, v97
v_cvt_pk_bf16_f32 v149, v98, v99
v_cvt_pk_bf16_f32 v150, v100, v101
v_cvt_pk_bf16_f32 v151, v102, v103
s_mov_b64 exec, s[48:49]
v_cvt_pk_bf16_f32 v180, v104, v105
v_cvt_pk_bf16_f32 v181, v106, v107
s_mov_b64 exec, -1
s_add_u32 m0, s41, 12288
s_nop 0
buffer_load_dwordx4 v2, s[32:35], s40 offen offset:2048 lds
s_add_u32 m0, s41, 12288
s_nop 0
buffer_load_dwordx4 v2, s[32:35], s40 offen offset:3072 lds
s_add_u32 s40, s40, 4096
s_add_u32 m0, s41, 16384
s_nop 0
buffer_load_dwordx4 v2, s[32:35], s40 offen offset:0 lds
buffer_load_dwordx4 a[48:51], v2, s[32:35], s42 offen
buffer_load_dwordx4 a[52:55], v2, s[32:35], s42 offen offset:1024
buffer_load_dwordx4 a[56:59], v11, s[32:35], s42 offen offset:2048
s_add_u32 s42, s42, 2560
buffer_load_dwordx4 a[112:115], v2, s[32:35], s46 offen offset:0
buffer_load_dwordx4 a[116:119], v2, s[32:35], s46 offen offset:1024
buffer_load_dwordx4 a[120:123], v2, s[32:35], s46 offen offset:2048
buffer_load_dwordx4 a[124:127], v2, s[32:35], s46 offen offset:3072
s_add_u32 s46, s46, 4096
s_waitcnt vmcnt(29)
ds_read_b128 v[112:115], v6 offset:3360
ds_read_b128 v[116:119], v6 offset:4032
ds_read_b128 v[120:123], v6 offset:4704
ds_read_b128 v[124:127], v6 offset:5376
ds_read_b128 v[128:131], v6 offset:6048
ds_read_b128 v[132:135], v6 offset:6384
s_waitcnt lgkmcnt(0)
v_cvt_pk_bf16_f32 v136, v112, v113
v_cvt_pk_bf16_f32 v137, v114, v115
v_cvt_pk_bf16_f32 v138, v116, v117
v_cvt_pk_bf16_f32 v139, v118, v119
v_cvt_pk_bf16_f32 v140, v120, v121
v_cvt_pk_bf16_f32 v141, v122, v123
v_cvt_pk_bf16_f32 v142, v124, v125
v_cvt_pk_bf16_f32 v143, v126, v127
v_cvt_pk_bf16_f32 v144, v128, v129
v_cvt_pk_bf16_f32 v145, v130, v131
v_cvt_pk_bf16_f32 v146, v132, v133
v_cvt_pk_bf16_f32 v147, v134, v135
v_cndmask_b32 v144, 0, v144, s[48:49]
v_cndmask_b32 v145, 0, v145, s[48:49]
v_cndmask_b32 v146, 0, v146, s[48:49]
v_cndmask_b32 v147, 0, v147, s[48:49]
s_nop 1
v_mfma_f32_32x32x16_bf16 v[96:111], v[136:139], a[12:15], 0
v_mfma_f32_32x32x16_bf16 v[96:111], v[140:143], a[16:19], v[96:111]
v_mfma_f32_32x32x16_bf16 v[96:111], v[144:147], a[20:23], v[96:111]
s_nop 12
v_add_f32 v188, 0x358637bd, v108
v_rcp_f32 v188, v188
s_nop 0
v_pk_mul_f32 v[96:97], v[96:97], v[188:189] op_sel_hi:[1,0]
v_pk_mul_f32 v[98:99], v[98:99], v[188:189] op_sel_hi:[1,0]
v_pk_mul_f32 v[100:101], v[100:101], v[188:189] op_sel_hi:[1,0]
v_pk_mul_f32 v[102:103], v[102:103], v[188:189] op_sel_hi:[1,0]
v_pk_mul_f32 v[104:105], v[104:105], v[188:189] op_sel_hi:[1,0]
v_pk_mul_f32 v[106:107], v[106:107], v[188:189] op_sel_hi:[1,0]
v_cvt_pk_bf16_f32 v152, v96, v97
v_cvt_pk_bf16_f32 v153, v98, v99
v_cvt_pk_bf16_f32 v154, v100, v101
v_cvt_pk_bf16_f32 v155, v102, v103
s_not_b64 exec, s[48:49]
v_cvt_pk_bf16_f32 v180, v104, v105
v_cvt_pk_bf16_f32 v181, v106, v107
s_mov_b64 exec, -1
s_add_u32 m0, s41, 16384
s_nop 0
buffer_load_dwordx4 v2, s[32:35], s40 offen offset:1024 lds
s_add_u32 m0, s41, 16384
s_nop 0
buffer_load_dwordx4 v2, s[32:35], s40 offen offset:2048 lds
s_add_u32 m0, s41, 16384
s_nop 0
buffer_load_dwordx4 v2, s[32:35], s40 offen offset:3072 lds
s_add_u32 s40, s40, 4096
buffer_load_dwordx4 a[60:63], v2, s[32:35], s42 offen
buffer_load_dwordx4 a[64:67], v2, s[32:35], s42 offen offset:1024
buffer_load_dwordx4 a[68:71], v11, s[32:35], s42 offen offset:2048
s_add_u32 s42, s42, 2560
buffer_load_dwordx4 a[128:131], v2, s[32:35], s46 offen offset:0
buffer_load_dwordx4 a[132:135], v2, s[32:35], s46 offen offset:1024
buffer_load_dwordx4 a[136:139], v2, s[32:35], s46 offen offset:2048
buffer_load_dwordx4 a[140:143], v2, s[32:35], s46 offen offset:3072
s_add_u32 s46, s46, 4096
s_waitcnt vmcnt(33)
ds_read_b128 v[112:115], v5 offset:6720
ds_read_b128 v[116:119], v5 offset:7392
ds_read_b128 v[120:123], v5 offset:8064
ds_read_b128 v[124:127], v5 offset:8736
ds_read_b128 v[128:131], v5 offset:9408
ds_read_b128 v[132:135], v5 offset:9744
s_waitcnt lgkmcnt(0)
v_cvt_pk_bf16_f32 v136, v112, v113
v_cvt_pk_bf16_f32 v137, v114, v115
v_cvt_pk_bf16_f32 v138, v116, v117
v_cvt_pk_bf16_f32 v139, v118, v119
v_cvt_pk_bf16_f32 v140, v120, v121
v_cvt_pk_bf16_f32 v141, v122, v123
v_cvt_pk_bf16_f32 v142, v124, v125
v_cvt_pk_bf16_f32 v143, v126, v127
v_cvt_pk_bf16_f32 v144, v128, v129
v_cvt_pk_bf16_f32 v145, v130, v131
v_cvt_pk_bf16_f32 v146, v132, v133
v_cvt_pk_bf16_f32 v147, v134, v135
v_cndmask_b32 v144, 0, v144, s[48:49]
v_cndmask_b32 v145, 0, v145, s[48:49]
v_cndmask_b32 v146, 0, v146, s[48:49]
v_cndmask_b32 v147, 0, v147, s[48:49]
s_nop 1
v_mfma_f32_32x32x16_bf16 v[96:111], v[136:139], a[24:27], 0
v_mfma_f32_32x32x16_bf16 v[96:111], v[140:143], a[28:31], v[96:111]
v_mfma_f32_32x32x16_bf16 v[96:111], v[144:147], a[32:35], v[96:111]
s_nop 12
v_add_f32 v188, 0x358637bd, v108
v_rcp_f32 v188, v188
s_nop 0
v_pk_mul_f32 v[96:97], v[96:97], v[188:189] op_sel_hi:[1,0]
v_pk_mul_f32 v[98:99], v[98:99], v[188:189] op_sel_hi:[1,0]
v_pk_mul_f32 v[100:101], v[100:101], v[188:189] op_sel_hi:[1,0]
v_pk_mul_f32 v[102:103], v[102:103], v[188:189] op_sel_hi:[1,0]
v_pk_mul_f32 v[104:105], v[104:105], v[188:189] op_sel_hi:[1,0]
v_pk_mul_f32 v[106:107], v[106:107], v[188:189] op_sel_hi:[1,0]
v_cvt_pk_bf16_f32 v156, v96, v97
v_cvt_pk_bf16_f32 v157, v98, v99
v_cvt_pk_bf16_f32 v158, v100, v101
v_cvt_pk_bf16_f32 v159, v102, v103
s_mov_b64 exec, s[48:49]
v_cvt_pk_bf16_f32 v182, v104, v105
v_cvt_pk_bf16_f32 v183, v106, v107
s_mov_b64 exec, -1
s_add_u32 m0, s41, 20480
s_nop 0
buffer_load_dwordx4 v2, s[32:35], s40 offen offset:0 lds
s_add_u32 m0, s41, 20480
s_nop 0
buffer_load_dwordx4 v2, s[32:35], s40 offen offset:1024 lds
s_add_u32 m0, s41, 20480
s_nop 0
buffer_load_dwordx4 v2, s[32:35], s40 offen offset:2048 lds
buffer_load_dwordx4 a[72:75], v2, s[32:35], s42 offen
buffer_load_dwordx4 a[76:79], v2, s[32:35], s42 offen offset:1024
buffer_load_dwordx4 a[80:83], v11, s[32:35], s42 offen offset:2048
s_add_u32 s42, s42, 2560
buffer_load_dwordx4 a[144:147], v2, s[32:35], s46 offen offset:0
buffer_load_dwordx4 a[148:151], v2, s[32:35], s46 offen offset:1024
buffer_load_dwordx4 a[152:155], v2, s[32:35], s46 offen offset:2048
buffer_load_dwordx4 a[156:159], v2, s[32:35], s46 offen offset:3072
s_add_u32 s46, s46, 4096
s_waitcnt vmcnt(34)
ds_read_b128 v[112:115], v6 offset:10080
ds_read_b128 v[116:119], v6 offset:10752
ds_read_b128 v[120:123], v6 offset:11424
ds_read_b128 v[124:127], v6 offset:12096
ds_read_b128 v[128:131], v6 offset:12768
ds_read_b128 v[132:135], v6 offset:13104
s_waitcnt lgkmcnt(0)
v_cvt_pk_bf16_f32 v136, v112, v113
v_cvt_pk_bf16_f32 v137, v114, v115
v_cvt_pk_bf16_f32 v138, v116, v117
v_cvt_pk_bf16_f32 v139, v118, v119
v_cvt_pk_bf16_f32 v140, v120, v121
v_cvt_pk_bf16_f32 v141, v122, v123
v_cvt_pk_bf16_f32 v142, v124, v125
v_cvt_pk_bf16_f32 v143, v126, v127
v_cvt_pk_bf16_f32 v144, v128, v129
v_cvt_pk_bf16_f32 v145, v130, v131
v_cvt_pk_bf16_f32 v146, v132, v133
v_cvt_pk_bf16_f32 v147, v134, v135
v_cndmask_b32 v144, 0, v144, s[48:49]
v_cndmask_b32 v145, 0, v145, s[48:49]
v_cndmask_b32 v146, 0, v146, s[48:49]
v_cndmask_b32 v147, 0, v147, s[48:49]
s_nop 1
v_mfma_f32_32x32x16_bf16 v[96:111], v[136:139], a[36:39], 0
v_mfma_f32_32x32x16_bf16 v[96:111], v[140:143], a[40:43], v[96:111]
v_mfma_f32_32x32x16_bf16 v[96:111], v[144:147], a[44:47], v[96:111]
s_nop 12
v_add_f32 v188, 0x358637bd, v108
v_rcp_f32 v188, v188
s_nop 0
v_pk_mul_f32 v[96:97], v[96:97], v[188:189] op_sel_hi:[1,0]
v_pk_mul_f32 v[98:99], v[98:99], v[188:189] op_sel_hi:[1,0]
v_pk_mul_f32 v[100:101], v[100:101], v[188:189] op_sel_hi:[1,0]
v_pk_mul_f32 v[102:103], v[102:103], v[188:189] op_sel_hi:[1,0]
v_pk_mul_f32 v[104:105], v[104:105], v[188:189] op_sel_hi:[1,0]
v_pk_mul_f32 v[106:107], v[106:107], v[188:189] op_sel_hi:[1,0]
v_cvt_pk_bf16_f32 v160, v96, v97
v_cvt_pk_bf16_f32 v161, v98, v99
v_cvt_pk_bf16_f32 v162, v100, v101
v_cvt_pk_bf16_f32 v163, v102, v103
s_not_b64 exec, s[48:49]
v_cvt_pk_bf16_f32 v182, v104, v105
v_cvt_pk_bf16_f32 v183, v106, v107
s_mov_b64 exec, -1
s_add_u32 m0, s41, 20480
s_nop 0
buffer_load_dwordx4 v2, s[32:35], s40 offen offset:3072 lds
s_add_u32 s40, s40, 4096
s_add_u32 m0, s41, 24576
s_nop 0
buffer_load_dwordx4 v2, s[32:35], s40 offen offset:0 lds
s_add_u32 m0, s41, 24576
s_nop 0
buffer_load_dwordx4 v2, s[32:35], s40 offen offset:1024 lds
s_add_u32 m0, s41, 24576
s_nop 0
buffer_load_dwordx4 v2, s[32:35], s40 offen offset:2048 lds
buffer_load_dwordx4 a[84:87], v2, s[32:35], s42 offen
buffer_load_dwordx4 a[88:91], v2, s[32:35], s42 offen offset:1024
buffer_load_dwordx4 a[92:95], v11, s[32:35], s42 offen offset:2048
s_add_u32 s42, s42, 2560
buffer_load_dwordx4 a[160:163], v2, s[32:35], s46 offen offset:0
buffer_load_dwordx4 a[164:167], v2, s[32:35], s46 offen offset:1024
buffer_load_dwordx4 a[168:171], v2, s[32:35], s46 offen offset:2048
buffer_load_dwordx4 a[172:175], v2, s[32:35], s46 offen offset:3072
s_add_u32 s46, s46, 4096
s_waitcnt vmcnt(35)
ds_read_b128 v[112:115], v5 offset:13440
ds_read_b128 v[116:119], v5 offset:14112
ds_read_b128 v[120:123], v5 offset:14784
ds_read_b128 v[124:127], v5 offset:15456
ds_read_b128 v[128:131], v5 offset:16128
ds_read_b128 v[132:135], v5 offset:16464
s_waitcnt lgkmcnt(0)
v_cvt_pk_bf16_f32 v136, v112, v113
v_cvt_pk_bf16_f32 v137, v114, v115
v_cvt_pk_bf16_f32 v138, v116, v117
v_cvt_pk_bf16_f32 v139, v118, v119
v_cvt_pk_bf16_f32 v140, v120, v121
v_cvt_pk_bf16_f32 v141, v122, v123
v_cvt_pk_bf16_f32 v142, v124, v125
v_cvt_pk_bf16_f32 v143, v126, v127
v_cvt_pk_bf16_f32 v144, v128, v129
v_cvt_pk_bf16_f32 v145, v130, v131
v_cvt_pk_bf16_f32 v146, v132, v133
v_cvt_pk_bf16_f32 v147, v134, v135
v_cndmask_b32 v144, 0, v144, s[48:49]
v_cndmask_b32 v145, 0, v145, s[48:49]
v_cndmask_b32 v146, 0, v146, s[48:49]
v_cndmask_b32 v147, 0, v147, s[48:49]
s_nop 1
v_mfma_f32_32x32x16_bf16 v[96:111], v[136:139], a[48:51], 0
v_mfma_f32_32x32x16_bf16 v[96:111], v[140:143], a[52:55], v[96:111]
v_mfma_f32_32x32x16_bf16 v[96:111], v[144:147], a[56:59], v[96:111]
s_nop 12
v_add_f32 v188, 0x358637bd, v108
v_rcp_f32 v188, v188
s_nop 0
v_pk_mul_f32 v[96:97], v[96:97], v[188:189] op_sel_hi:[1,0]
v_pk_mul_f32 v[98:99], v[98:99], v[188:189] op_sel_hi:[1,0]
v_pk_mul_f32 v[100:101], v[100:101], v[188:189] op_sel_hi:[1,0]
v_pk_mul_f32 v[102:103], v[102:103], v[188:189] op_sel_hi:[1,0]
v_pk_mul_f32 v[104:105], v[104:105], v[188:189] op_sel_hi:[1,0]
v_pk_mul_f32 v[106:107], v[106:107], v[188:189] op_sel_hi:[1,0]
v_cvt_pk_bf16_f32 v164, v96, v97
v_cvt_pk_bf16_f32 v165, v98, v99
v_cvt_pk_bf16_f32 v166, v100, v101
v_cvt_pk_bf16_f32 v167, v102, v103
s_mov_b64 exec, s[48:49]
v_cvt_pk_bf16_f32 v184, v104, v105
v_cvt_pk_bf16_f32 v185, v106, v107
s_mov_b64 exec, -1
buffer_load_dwordx4 a[176:179], v2, s[32:35], s46 offen offset:0
buffer_load_dwordx4 a[180:183], v2, s[32:35], s46 offen offset:1024
buffer_load_dwordx4 a[184:187], v2, s[32:35], s46 offen offset:2048
buffer_load_dwordx4 a[188:191], v2, s[32:35], s46 offen offset:3072
s_add_u32 s46, s46, 4096
buffer_load_dwordx4 a[192:195], v2, s[32:35], s46 offen offset:0
buffer_load_dwordx4 a[196:199], v2, s[32:35], s46 offen offset:1024
buffer_load_dwordx4 a[200:203], v2, s[32:35], s46 offen offset:2048
buffer_load_dwordx4 a[204:207], v2, s[32:35], s46 offen offset:3072
s_add_u32 s46, s46, 4096
buffer_load_dwordx4 a[208:211], v2, s[32:35], s46 offen offset:0
buffer_load_dwordx4 a[212:215], v2, s[32:35], s46 offen offset:1024
s_waitcnt vmcnt(35)
ds_read_b128 v[112:115], v6 offset:16800
ds_read_b128 v[116:119], v6 offset:17472
ds_read_b128 v[120:123], v6 offset:18144
ds_read_b128 v[124:127], v6 offset:18816
ds_read_b128 v[128:131], v6 offset:19488
ds_read_b128 v[132:135], v6 offset:19824
s_waitcnt lgkmcnt(0)
v_cvt_pk_bf16_f32 v136, v112, v113
v_cvt_pk_bf16_f32 v137, v114, v115
v_cvt_pk_bf16_f32 v138, v116, v117
v_cvt_pk_bf16_f32 v139, v118, v119
v_cvt_pk_bf16_f32 v140, v120, v121
v_cvt_pk_bf16_f32 v141, v122, v123
v_cvt_pk_bf16_f32 v142, v124, v125
v_cvt_pk_bf16_f32 v143, v126, v127
v_cvt_pk_bf16_f32 v144, v128, v129
v_cvt_pk_bf16_f32 v145, v130, v131
v_cvt_pk_bf16_f32 v146, v132, v133
v_cvt_pk_bf16_f32 v147, v134, v135
v_cndmask_b32 v144, 0, v144, s[48:49]
v_cndmask_b32 v145, 0, v145, s[48:49]
v_cndmask_b32 v146, 0, v146, s[48:49]
v_cndmask_b32 v147, 0, v147, s[48:49]
s_nop 1
v_mfma_f32_32x32x16_bf16 v[96:111], v[136:139], a[60:63], 0
v_mfma_f32_32x32x16_bf16 v[96:111], v[140:143], a[64:67], v[96:111]
v_mfma_f32_32x32x16_bf16 v[96:111], v[144:147], a[68:71], v[96:111]
s_nop 12
v_add_f32 v188, 0x358637bd, v108
v_rcp_f32 v188, v188
s_nop 0
v_pk_mul_f32 v[96:97], v[96:97], v[188:189] op_sel_hi:[1,0]
v_pk_mul_f32 v[98:99], v[98:99], v[188:189] op_sel_hi:[1,0]
v_pk_mul_f32 v[100:101], v[100:101], v[188:189] op_sel_hi:[1,0]
v_pk_mul_f32 v[102:103], v[102:103], v[188:189] op_sel_hi:[1,0]
v_pk_mul_f32 v[104:105], v[104:105], v[188:189] op_sel_hi:[1,0]
v_pk_mul_f32 v[106:107], v[106:107], v[188:189] op_sel_hi:[1,0]
v_cvt_pk_bf16_f32 v168, v96, v97
v_cvt_pk_bf16_f32 v169, v98, v99
v_cvt_pk_bf16_f32 v170, v100, v101
v_cvt_pk_bf16_f32 v171, v102, v103
s_not_b64 exec, s[48:49]
v_cvt_pk_bf16_f32 v184, v104, v105
v_cvt_pk_bf16_f32 v185, v106, v107
s_mov_b64 exec, -1
buffer_load_dwordx4 a[216:219], v2, s[32:35], s46 offen offset:2048
buffer_load_dwordx4 a[220:223], v2, s[32:35], s46 offen offset:3072
s_add_u32 s46, s46, 4096
buffer_load_dwordx4 a[224:227], v2, s[32:35], s46 offen offset:0
buffer_load_dwordx4 a[228:231], v2, s[32:35], s46 offen offset:1024
buffer_load_dwordx4 a[232:235], v2, s[32:35], s46 offen offset:2048
buffer_load_dwordx4 a[236:239], v2, s[32:35], s46 offen offset:3072
s_add_u32 s46, s46, 4096
buffer_load_dwordx4 a[240:243], v2, s[32:35], s46 offen offset:0
buffer_load_dwordx4 a[244:247], v2, s[32:35], s46 offen offset:1024
buffer_load_dwordx4 a[248:251], v2, s[32:35], s46 offen offset:2048
buffer_load_dwordx4 a[252:255], v2, s[32:35], s46 offen offset:3072
s_add_u32 s46, s46, 4096
s_waitcnt vmcnt(35)
ds_read_b128 v[112:115], v5 offset:20160
ds_read_b128 v[116:119], v5 offset:20832
ds_read_b128 v[120:123], v5 offset:21504
ds_read_b128 v[124:127], v5 offset:22176
ds_read_b128 v[128:131], v5 offset:22848
ds_read_b128 v[132:135], v5 offset:23184
s_waitcnt lgkmcnt(0)
v_cvt_pk_bf16_f32 v136, v112, v113
v_cvt_pk_bf16_f32 v137, v114, v115
v_cvt_pk_bf16_f32 v138, v116, v117
v_cvt_pk_bf16_f32 v139, v118, v119
v_cvt_pk_bf16_f32 v140, v120, v121
v_cvt_pk_bf16_f32 v141, v122, v123
v_cvt_pk_bf16_f32 v142, v124, v125
v_cvt_pk_bf16_f32 v143, v126, v127
v_cvt_pk_bf16_f32 v144, v128, v129
v_cvt_pk_bf16_f32 v145, v130, v131
v_cvt_pk_bf16_f32 v146, v132, v133
v_cvt_pk_bf16_f32 v147, v134, v135
v_cndmask_b32 v144, 0, v144, s[48:49]
v_cndmask_b32 v145, 0, v145, s[48:49]
v_cndmask_b32 v146, 0, v146, s[48:49]
v_cndmask_b32 v147, 0, v147, s[48:49]
s_nop 1
v_mfma_f32_32x32x16_bf16 v[96:111], v[136:139], a[72:75], 0
v_mfma_f32_32x32x16_bf16 v[96:111], v[140:143], a[76:79], v[96:111]
v_mfma_f32_32x32x16_bf16 v[96:111], v[144:147], a[80:83], v[96:111]
s_nop 12
v_add_f32 v188, 0x358637bd, v108
v_rcp_f32 v188, v188
s_nop 0
v_pk_mul_f32 v[96:97], v[96:97], v[188:189] op_sel_hi:[1,0]
v_pk_mul_f32 v[98:99], v[98:99], v[188:189] op_sel_hi:[1,0]
v_pk_mul_f32 v[100:101], v[100:101], v[188:189] op_sel_hi:[1,0]
v_pk_mul_f32 v[102:103], v[102:103], v[188:189] op_sel_hi:[1,0]
v_pk_mul_f32 v[104:105], v[104:105], v[188:189] op_sel_hi:[1,0]
v_pk_mul_f32 v[106:107], v[106:107], v[188:189] op_sel_hi:[1,0]
v_cvt_pk_bf16_f32 v172, v96, v97
v_cvt_pk_bf16_f32 v173, v98, v99
v_cvt_pk_bf16_f32 v174, v100, v101
v_cvt_pk_bf16_f32 v175, v102, v103
s_mov_b64 exec, s[48:49]
v_cvt_pk_bf16_f32 v186, v104, v105
v_cvt_pk_bf16_f32 v187, v106, v107
s_mov_b64 exec, -1
buffer_load_dwordx4 v[200:203], v2, s[32:35], s46 offen offset:0
buffer_load_dwordx4 v[204:207], v2, s[32:35], s46 offen offset:1024
buffer_load_dwordx4 v[208:211], v2, s[32:35], s46 offen offset:2048
buffer_load_dwordx4 v[212:215], v2, s[32:35], s46 offen offset:3072
s_add_u32 s46, s46, 4096
buffer_load_dwordx4 v[216:219], v2, s[32:35], s46 offen offset:0
buffer_load_dwordx4 v[220:223], v2, s[32:35], s46 offen offset:1024
buffer_load_dwordx4 v[224:227], v2, s[32:35], s46 offen offset:2048
buffer_load_dwordx4 v[228:231], v2, s[32:35], s46 offen offset:3072
s_add_u32 s46, s46, 4096
buffer_load_dwordx4 v[232:235], v2, s[32:35], s46 offen offset:0
buffer_load_dwordx4 v[236:239], v2, s[32:35], s46 offen offset:1024
s_waitcnt vmcnt(34)
ds_read_b128 v[112:115], v6 offset:23520
ds_read_b128 v[116:119], v6 offset:24192
ds_read_b128 v[120:123], v6 offset:24864
ds_read_b128 v[124:127], v6 offset:25536
ds_read_b128 v[128:131], v6 offset:26208
ds_read_b128 v[132:135], v6 offset:26544
s_waitcnt lgkmcnt(0)
v_cvt_pk_bf16_f32 v136, v112, v113
v_cvt_pk_bf16_f32 v137, v114, v115
v_cvt_pk_bf16_f32 v138, v116, v117
v_cvt_pk_bf16_f32 v139, v118, v119
v_cvt_pk_bf16_f32 v140, v120, v121
v_cvt_pk_bf16_f32 v141, v122, v123
v_cvt_pk_bf16_f32 v142, v124, v125
v_cvt_pk_bf16_f32 v143, v126, v127
v_cvt_pk_bf16_f32 v144, v128, v129
v_cvt_pk_bf16_f32 v145, v130, v131
v_cvt_pk_bf16_f32 v146, v132, v133
v_cvt_pk_bf16_f32 v147, v134, v135
v_cndmask_b32 v144, 0, v144, s[48:49]
v_cndmask_b32 v145, 0, v145, s[48:49]
v_cndmask_b32 v146, 0, v146, s[48:49]
v_cndmask_b32 v147, 0, v147, s[48:49]
s_nop 1
v_mfma_f32_32x32x16_bf16 v[96:111], v[136:139], a[84:87], 0
v_mfma_f32_32x32x16_bf16 v[96:111], v[140:143], a[88:91], v[96:111]
v_mfma_f32_32x32x16_bf16 v[96:111], v[144:147], a[92:95], v[96:111]
s_nop 12
v_add_f32 v188, 0x358637bd, v108
v_rcp_f32 v188, v188
s_nop 0
v_pk_mul_f32 v[96:97], v[96:97], v[188:189] op_sel_hi:[1,0]
v_pk_mul_f32 v[98:99], v[98:99], v[188:189] op_sel_hi:[1,0]
v_pk_mul_f32 v[100:101], v[100:101], v[188:189] op_sel_hi:[1,0]
v_pk_mul_f32 v[102:103], v[102:103], v[188:189] op_sel_hi:[1,0]
v_pk_mul_f32 v[104:105], v[104:105], v[188:189] op_sel_hi:[1,0]
v_pk_mul_f32 v[106:107], v[106:107], v[188:189] op_sel_hi:[1,0]
v_cvt_pk_bf16_f32 v176, v96, v97
v_cvt_pk_bf16_f32 v177, v98, v99
v_cvt_pk_bf16_f32 v178, v100, v101
v_cvt_pk_bf16_f32 v179, v102, v103
s_not_b64 exec, s[48:49]
v_cvt_pk_bf16_f32 v186, v104, v105
v_cvt_pk_bf16_f32 v187, v106, v107
s_mov_b64 exec, -1
v_mfma_f32_32x32x16_bf16 v[16:31], a[96:99], v[148:151], v[16:31]
v_mfma_f32_32x32x16_bf16 v[32:47], a[100:103], v[148:151], v[32:47]
v_mfma_f32_32x32x16_bf16 v[48:63], a[104:107], v[148:151], v[48:63]
v_mfma_f32_32x32x16_bf16 v[64:79], a[108:111], v[148:151], v[64:79]
v_mfma_f32_32x32x16_bf16 v[80:95], a[112:115], v[148:151], v[80:95]
v_mfma_f32_32x32x16_bf16 v[16:31], a[116:119], v[152:155], v[16:31]
v_mfma_f32_32x32x16_bf16 v[32:47], a[120:123], v[152:155], v[32:47]
v_mfma_f32_32x32x16_bf16 v[48:63], a[124:127], v[152:155], v[48:63]
v_mfma_f32_32x32x16_bf16 v[64:79], a[128:131], v[152:155], v[64:79]
v_mfma_f32_32x32x16_bf16 v[80:95], a[132:135], v[152:155], v[80:95]
v_mfma_f32_32x32x16_bf16 v[16:31], a[136:139], v[156:159], v[16:31]
v_mfma_f32_32x32x16_bf16 v[32:47], a[140:143], v[156:159], v[32:47]
v_mfma_f32_32x32x16_bf16 v[48:63], a[144:147], v[156:159], v[48:63]
v_mfma_f32_32x32x16_bf16 v[64:79], a[148:151], v[156:159], v[64:79]
v_mfma_f32_32x32x16_bf16 v[80:95], a[152:155], v[156:159], v[80:95]
s_waitcnt vmcnt(30)
v_mfma_f32_32x32x16_bf16 v[16:31], a[156:159], v[160:163], v[16:31]
v_mfma_f32_32x32x16_bf16 v[32:47], a[160:163], v[160:163], v[32:47]
v_mfma_f32_32x32x16_bf16 v[48:63], a[164:167], v[160:163], v[48:63]
v_mfma_f32_32x32x16_bf16 v[64:79], a[168:171], v[160:163], v[64:79]
v_mfma_f32_32x32x16_bf16 v[80:95], a[172:175], v[160:163], v[80:95]
s_waitcnt vmcnt(25)
v_mfma_f32_32x32x16_bf16 v[16:31], a[176:179], v[180:183], v[16:31]
v_mfma_f32_32x32x16_bf16 v[32:47], a[180:183], v[180:183], v[32:47]
v_mfma_f32_32x32x16_bf16 v[48:63], a[184:187], v[180:183], v[48:63]
v_mfma_f32_32x32x16_bf16 v[64:79], a[188:191], v[180:183], v[64:79]
v_mfma_f32_32x32x16_bf16 v[80:95], a[192:195], v[180:183], v[80:95]
s_waitcnt vmcnt(20)
v_mfma_f32_32x32x16_bf16 v[16:31], a[196:199], v[164:167], v[16:31]
v_mfma_f32_32x32x16_bf16 v[32:47], a[200:203], v[164:167], v[32:47]
v_mfma_f32_32x32x16_bf16 v[48:63], a[204:207], v[164:167], v[48:63]
v_mfma_f32_32x32x16_bf16 v[64:79], a[208:211], v[164:167], v[64:79]
v_mfma_f32_32x32x16_bf16 v[80:95], a[212:215], v[164:167], v[80:95]
s_waitcnt vmcnt(15)
v_mfma_f32_32x32x16_bf16 v[16:31], a[216:219], v[168:171], v[16:31]
v_mfma_f32_32x32x16_bf16 v[32:47], a[220:223], v[168:171], v[32:47]
v_mfma_f32_32x32x16_bf16 v[48:63], a[224:227], v[168:171], v[48:63]
v_mfma_f32_32x32x16_bf16 v[64:79], a[228:231], v[168:171], v[64:79]
v_mfma_f32_32x32x16_bf16 v[80:95], a[232:235], v[168:171], v[80:95]
s_waitcnt vmcnt(10)
v_mfma_f32_32x32x16_bf16 v[16:31], a[236:239], v[172:175], v[16:31]
v_mfma_f32_32x32x16_bf16 v[32:47], a[240:243], v[172:175], v[32:47]
v_mfma_f32_32x32x16_bf16 v[48:63], a[244:247], v[172:175], v[48:63]
v_mfma_f32_32x32x16_bf16 v[64:79], a[248:251], v[172:175], v[64:79]
v_mfma_f32_32x32x16_bf16 v[80:95], a[252:255], v[172:175], v[80:95]
s_waitcnt vmcnt(5)
v_mfma_f32_32x32x16_bf16 v[16:31], v[200:203], v[176:179], v[16:31]
v_mfma_f32_32x32x16_bf16 v[32:47], v[204:207], v[176:179], v[32:47]
v_mfma_f32_32x32x16_bf16 v[48:63], v[208:211], v[176:179], v[48:63]
v_mfma_f32_32x32x16_bf16 v[64:79], v[212:215], v[176:179], v[64:79]
v_mfma_f32_32x32x16_bf16 v[80:95], v[216:219], v[176:179], v[80:95]
s_waitcnt vmcnt(0)
v_mfma_f32_32x32x16_bf16 v[16:31], v[220:223], v[184:187], v[16:31]
v_mfma_f32_32x32x16_bf16 v[32:47], v[224:227], v[184:187], v[32:47]
v_mfma_f32_32x32x16_bf16 v[48:63], v[228:231], v[184:187], v[48:63]
v_mfma_f32_32x32x16_bf16 v[64:79], v[232:235], v[184:187], v[64:79]
v_mfma_f32_32x32x16_bf16 v[80:95], v[236:239], v[184:187], v[80:95]
s_waitcnt vmcnt(0)
s_barrier
s_nop 11
s_add_u32 s50, s26, 1
s_and_b32 s50, s50, 3
s_mul_i32 s50, s50, 15360
s_add_u32 s50, s50, 0
v_add_u32 v9, s50, v2
ds_write_b128 v9, v[20:23] offset:0
ds_write_b128 v9, v[36:39] offset:1024
ds_write_b128 v9, v[52:55] offset:2048
ds_write_b128 v9, v[68:71] offset:3072
ds_write_b128 v9, v[84:87] offset:4096
s_add_u32 s50, s26, 2
s_and_b32 s50, s50, 3
s_mul_i32 s50, s50, 15360
s_add_u32 s50, s50, 5120
v_add_u32 v10, s50, v2
ds_write_b128 v10, v[24:27] offset:0
ds_write_b128 v10, v[40:43] offset:1024
ds_write_b128 v10, v[56:59] offset:2048
ds_write_b128 v10, v[72:75] offset:3072
ds_write_b128 v10, v[88:91] offset:4096
s_add_u32 s50, s26, 3
s_and_b32 s50, s50, 3
s_mul_i32 s50, s50, 15360
s_add_u32 s50, s50, 10240
v_add_u32 v11, s50, v2
ds_write_b128 v11, v[28:31] offset:0
ds_write_b128 v11, v[44:47] offset:1024
ds_write_b128 v11, v[60:63] offset:2048
ds_write_b128 v11, v[76:79] offset:3072
ds_write_b128 v11, v[92:95] offset:4096
s_mul_i32 s50, s26, 15360
v_add_u32 v8, s50, v2
s_waitcnt lgkmcnt(0)
s_barrier
ds_read_b128 v[96:99], v8 offset:0
ds_read_b128 v[100:103], v8 offset:1024
ds_read_b128 v[104:107], v8 offset:2048
ds_read_b128 v[108:111], v8 offset:3072
ds_read_b128 v[112:115], v8 offset:4096
ds_read_b128 v[116:119], v8 offset:5120
ds_read_b128 v[120:123], v8 offset:6144
ds_read_b128 v[124:127], v8 offset:7168
ds_read_b128 v[128:131], v8 offset:8192
ds_read_b128 v[132:135], v8 offset:9216
ds_read_b128 v[136:139], v8 offset:10240
ds_read_b128 v[140:143], v8 offset:11264
ds_read_b128 v[144:147], v8 offset:12288
ds_read_b128 v[148:151], v8 offset:13312
ds_read_b128 v[152:155], v8 offset:14336
s_waitcnt lgkmcnt(10)
v_pk_add_f32 v[160:161], v[16:17], v[96:97]
v_pk_add_f32 v[162:163], v[18:19], v[98:99]
v_pk_add_f32 v[164:165], v[32:33], v[100:101]
v_pk_add_f32 v[166:167], v[34:35], v[102:103]
v_pk_add_f32 v[168:169], v[48:49], v[104:105]
v_pk_add_f32 v[170:171], v[50:51], v[106:107]
v_pk_add_f32 v[172:173], v[64:65], v[108:109]
v_pk_add_f32 v[174:175], v[66:67], v[110:111]
v_pk_add_f32 v[176:177], v[80:81], v[112:113]
v_pk_add_f32 v[178:179], v[82:83], v[114:115]
s_waitcnt lgkmcnt(5)
v_pk_add_f32 v[160:161], v[160:161], v[116:117]
v_pk_add_f32 v[162:163], v[162:163], v[118:119]
v_pk_add_f32 v[164:165], v[164:165], v[120:121]
v_pk_add_f32 v[166:167], v[166:167], v[122:123]
v_pk_add_f32 v[168:169], v[168:169], v[124:125]
v_pk_add_f32 v[170:171], v[170:171], v[126:127]
v_pk_add_f32 v[172:173], v[172:173], v[128:129]
v_pk_add_f32 v[174:175], v[174:175], v[130:131]
v_pk_add_f32 v[176:177], v[176:177], v[132:133]
v_pk_add_f32 v[178:179], v[178:179], v[134:135]
s_waitcnt lgkmcnt(0)
v_pk_add_f32 v[160:161], v[160:161], v[136:137]
v_pk_add_f32 v[162:163], v[162:163], v[138:139]
v_pk_add_f32 v[164:165], v[164:165], v[140:141]
v_pk_add_f32 v[166:167], v[166:167], v[142:143]
v_pk_add_f32 v[168:169], v[168:169], v[144:145]
v_pk_add_f32 v[170:171], v[170:171], v[146:147]
v_pk_add_f32 v[172:173], v[172:173], v[148:149]
v_pk_add_f32 v[174:175], v[174:175], v[150:151]
v_pk_add_f32 v[176:177], v[176:177], v[152:153]
v_pk_add_f32 v[178:179], v[178:179], v[154:155]
v_mul_u32_u24 v8, 320, v3
v_lshlrev_b32 v9, 3, v4
v_add_u32 v8, v8, v9
s_lshl_b32 s50, s26, 4
s_add_u32 s50, s50, 110592
v_add_u32 v8, s50, v8
ds_read_b64 v[16:17], v8 offset:0
ds_read_b64 v[18:19], v8 offset:64
ds_read_b64 v[20:21], v8 offset:128
ds_read_b64 v[22:23], v8 offset:192
ds_read_b64 v[24:25], v8 offset:256
s_waitcnt lgkmcnt(0)
v_lshlrev_b32 v60, 16, v16
v_and_b32 v61, 0xffff0000, v16
v_pk_add_f32 v[60:61], v[60:61], v[160:161]
v_cvt_pk_bf16_f32 v40, v60, v61
v_lshlrev_b32 v60, 16, v17
v_and_b32 v61, 0xffff0000, v17
v_pk_add_f32 v[60:61], v[60:61], v[162:163]
v_cvt_pk_bf16_f32 v41, v60, v61
v_lshlrev_b32 v60, 16, v18
v_and_b32 v61, 0xffff0000, v18
v_pk_add_f32 v[60:61], v[60:61], v[164:165]
v_cvt_pk_bf16_f32 v42, v60, v61
v_lshlrev_b32 v60, 16, v19
v_and_b32 v61, 0xffff0000, v19
v_pk_add_f32 v[60:61], v[60:61], v[166:167]
v_cvt_pk_bf16_f32 v43, v60, v61
v_lshlrev_b32 v60, 16, v20
v_and_b32 v61, 0xffff0000, v20
v_pk_add_f32 v[60:61], v[60:61], v[168:169]
v_cvt_pk_bf16_f32 v44, v60, v61
v_lshlrev_b32 v60, 16, v21
v_and_b32 v61, 0xffff0000, v21
v_pk_add_f32 v[60:61], v[60:61], v[170:171]
v_cvt_pk_bf16_f32 v45, v60, v61
v_lshlrev_b32 v60, 16, v22
v_and_b32 v61, 0xffff0000, v22
v_pk_add_f32 v[60:61], v[60:61], v[172:173]
v_cvt_pk_bf16_f32 v46, v60, v61
v_lshlrev_b32 v60, 16, v23
v_and_b32 v61, 0xffff0000, v23
v_pk_add_f32 v[60:61], v[60:61], v[174:175]
v_cvt_pk_bf16_f32 v47, v60, v61
v_lshlrev_b32 v60, 16, v24
v_and_b32 v61, 0xffff0000, v24
v_pk_add_f32 v[60:61], v[60:61], v[176:177]
v_cvt_pk_bf16_f32 v48, v60, v61
v_lshlrev_b32 v60, 16, v25
v_and_b32 v61, 0xffff0000, v25
v_pk_add_f32 v[60:61], v[60:61], v[178:179]
v_cvt_pk_bf16_f32 v49, v60, v61
v_lshlrev_b32 v8, 4, v3
v_lshlrev_b32 v9, 3, v4
v_add_u32 v8, v8, v9
s_mul_i32 s50, s29, 40
s_mul_i32 s51, s30, 10
s_add_u32 s50, s50, s51
s_lshr_b32 s51, s26, 1
s_add_u32 s50, s50, s51
s_lshl_b32 s50, s50, 10
s_and_b32 s51, s26, 1
s_lshl_b32 s51, s51, 9
s_add_u32 s50, s50, s51
s_add_u32 s50, s50, 13041664
buffer_store_dwordx2 v[40:41], v8, s[32:35], s50 offen sc0 sc1
s_add_u32 s50, s50, 2048
buffer_store_dwordx2 v[42:43], v8, s[32:35], s50 offen sc0 sc1
s_add_u32 s50, s50, 2048
buffer_store_dwordx2 v[44:45], v8, s[32:35], s50 offen sc0 sc1
s_add_u32 s50, s50, 2048
buffer_store_dwordx2 v[46:47], v8, s[32:35], s50 offen sc0 sc1
s_add_u32 s50, s50, 2048
buffer_store_dwordx2 v[48:49], v8, s[32:35], s50 offen sc0 sc1
s_add_u32 s50, s50, 2048
v_mov_b32 v62, 0
v_mov_b32 v63, 0
v_mov_b32 v64, 0
v_mov_b32 v65, 0
v_lshlrev_b32 v60, 16, v40
v_and_b32 v61, 0xffff0000, v40
v_pk_add_f32 v[62:63], v[62:63], v[60:61]
v_pk_fma_f32 v[64:65], v[60:61], v[60:61], v[64:65]
v_lshlrev_b32 v60, 16, v41
v_and_b32 v61, 0xffff0000, v41
v_pk_add_f32 v[62:63], v[62:63], v[60:61]
v_pk_fma_f32 v[64:65], v[60:61], v[60:61], v[64:65]
v_lshlrev_b32 v60, 16, v42
v_and_b32 v61, 0xffff0000, v42
v_pk_add_f32 v[62:63], v[62:63], v[60:61]
v_pk_fma_f32 v[64:65], v[60:61], v[60:61], v[64:65]
v_lshlrev_b32 v60, 16, v43
v_and_b32 v61, 0xffff0000, v43
v_pk_add_f32 v[62:63], v[62:63], v[60:61]
v_pk_fma_f32 v[64:65], v[60:61], v[60:61], v[64:65]
v_lshlrev_b32 v60, 16, v44
v_and_b32 v61, 0xffff0000, v44
v_pk_add_f32 v[62:63], v[62:63], v[60:61]
v_pk_fma_f32 v[64:65], v[60:61], v[60:61], v[64:65]
v_lshlrev_b32 v60, 16, v45
v_and_b32 v61, 0xffff0000, v45
v_pk_add_f32 v[62:63], v[62:63], v[60:61]
v_pk_fma_f32 v[64:65], v[60:61], v[60:61], v[64:65]
v_lshlrev_b32 v60, 16, v46
v_and_b32 v61, 0xffff0000, v46
v_pk_add_f32 v[62:63], v[62:63], v[60:61]
v_pk_fma_f32 v[64:65], v[60:61], v[60:61], v[64:65]
v_lshlrev_b32 v60, 16, v47
v_and_b32 v61, 0xffff0000, v47
v_pk_add_f32 v[62:63], v[62:63], v[60:61]
v_pk_fma_f32 v[64:65], v[60:61], v[60:61], v[64:65]
v_lshlrev_b32 v60, 16, v48
v_and_b32 v61, 0xffff0000, v48
v_pk_add_f32 v[62:63], v[62:63], v[60:61]
v_pk_fma_f32 v[64:65], v[60:61], v[60:61], v[64:65]
v_lshlrev_b32 v60, 16, v49
v_and_b32 v61, 0xffff0000, v49
v_pk_add_f32 v[62:63], v[62:63], v[60:61]
v_pk_fma_f32 v[64:65], v[60:61], v[60:61], v[64:65]
v_add_f32 v66, v62, v63
v_add_f32 v67, v64, v65
s_lshl_b32 s50, s26, 9
s_add_u32 s50, s50, 120832
v_lshlrev_b32 v8, 3, v1
v_add_u32 v8, s50, v8
ds_write_b64 v8, v[66:67]
s_waitcnt lgkmcnt(0)
s_barrier
s_cmp_lg_u32 s26, 0
s_cbranch_scc1 Lp2_end
s_mov_b64 exec, s[48:49]
v_lshlrev_b32 v8, 3, v3
v_add_u32 v8, 120832, v8
ds_read_b64 v[70:71], v8 offset:0
ds_read_b64 v[72:73], v8 offset:256
ds_read_b64 v[74:75], v8 offset:512
ds_read_b64 v[76:77], v8 offset:768
ds_read_b64 v[78:79], v8 offset:1024
ds_read_b64 v[80:81], v8 offset:1280
ds_read_b64 v[82:83], v8 offset:1536
ds_read_b64 v[84:85], v8 offset:1792
s_waitcnt lgkmcnt(0)
v_pk_add_f32 v[70:71], v[70:71], v[72:73]
v_pk_add_f32 v[70:71], v[70:71], v[74:75]
v_pk_add_f32 v[70:71], v[70:71], v[76:77]
v_pk_add_f32 v[70:71], v[70:71], v[78:79]
v_pk_add_f32 v[70:71], v[70:71], v[80:81]
v_pk_add_f32 v[70:71], v[70:71], v[82:83]
v_pk_add_f32 v[70:71], v[70:71], v[84:85]
v_lshlrev_b32 v8, 5, v3
s_lshl_b32 s50, s29, 10
s_lshl_b32 s51, s30, 3
s_add_u32 s50, s50, s51
s_add_u32 s50, s50, 15663104
buffer_store_dwordx2 v[70:71], v8, s[32:35], s50 offen
s_mov_b64 exec, -1
Lp2_end:
Lp2_exit:
s_endpgm
.globl p3_kernel
.p2align 8
.type p3_kernel,@function
p3_kernel:
s_cmp_ge_u32 s2, 256
s_cbranch_scc1 Lp3_exit
s_load_dwordx2 s[24:25], s[0:1], 80
v_lshrrev_b32 v1, 6, v0
s_and_b32 s27, s2, 7
s_lshr_b32 s28, s2, 3
v_readfirstlane_b32 s26, v1
s_lshr_b32 s29, s27, 2
s_lshl_b32 s29, s29, 3
s_lshr_b32 s31, s28, 2
s_add_u32 s29, s29, s31
s_and_b32 s30, s27, 3
s_lshl_b32 s30, s30, 2
s_and_b32 s31, s28, 3
s_add_u32 s30, s30, s31
s_mul_i32 s30, s30, 27
s_lshr_b32 s30, s30, 2
s_waitcnt lgkmcnt(0)
s_mov_b32 s32, s24
s_mov_b32 s33, s25
s_mov_b32 s34, 0x1600000
s_mov_b32 s35, 0x00020000
s_cmp_lt_u32 s26, 4
s_cbranch_scc1 Lp3_cons
s_sub_u32 s26, s26, 4
s_cmp_lt_u32 s26, 2
s_cbranch_scc0 Lp3_ld1
v_and_b32 v1, 63, v0
v_lshlrev_b32 v2, 4, v1
v_add_u32 v4, 0, v2
v_add_u32 v5, 40960, v2
v_add_u32 v6, 81920, v2
v_add_u32 v7, 122880, v2
s_and_b32 s40, s26, 1
s_mul_i32 s41, s30, 41984
s_lshl_b32 s42, s40, 10
s_add_u32 s41, s41, s42
s_add_u32 s41, s41, 6225920
v_add_u32 v10, 0, v2
v_add_u32 v11, 39936, v2
s_lshl_b32 s43, s29, 2
s_lshr_b32 s44, s26, 1
s_lshl_b32 s45, s44, 1
s_add_u32 s43, s43, s45
s_mul_i32 s43, s43, 40960
s_add_u32 s43, s43, s42
s_add_u32 s43, s43, 13041664
s_mul_i32 s46, s40, 7168
s_add_u32 s46, s46, 0
s_lshl_b32 s47, s40, 12
s_lshl_b32 s45, s45, 10
s_add_u32 s47, s47, s45
s_add_u32 s47, s47, 14336
s_mov_b32 s48, 0
s_add_u32 m0, s48, s47
s_nop 0
buffer_load_dwordx4 v10, s[32:35], s43 offen offset:0 lds
buffer_load_dwordx4 v11, s[32:35], s43 offen offset:1024 lds
s_add_u32 m0, s48, s46
s_nop 0
buffer_load_dwordx4 v4, s[32:35], s41 offen offset:0 lds
buffer_load_dwordx4 v5, s[32:35], s41 offen offset:1024 lds
buffer_load_dwordx4 v6, s[32:35], s41 offen offset:2048 lds
buffer_load_dwordx4 v7, s[32:35], s41 offen offset:3072 lds
s_add_u32 s41, s41, 2048
s_add_u32 s43, s43, 2048
s_add_u32 s48, s48, 22528
s_cmp_ge_u32 s48, 157696
s_cselect_b32 s48, 0, s48
s_add_u32 m0, s48, s47
s_nop 0
buffer_load_dwordx4 v10, s[32:35], s43 offen offset:0 lds
buffer_load_dwordx4 v11, s[32:35], s43 offen offset:1024 lds
s_add_u32 m0, s48, s46
s_nop 0
buffer_load_dwordx4 v4, s[32:35], s41 offen offset:0 lds
buffer_load_dwordx4 v5, s[32:35], s41 offen offset:1024 lds
buffer_load_dwordx4 v6, s[32:35], s41 offen offset:2048 lds
buffer_load_dwordx4 v7, s[32:35], s41 offen offset:3072 lds
s_add_u32 s41, s41, 2048
s_add_u32 s43, s43, 2048
s_add_u32 s48, s48, 22528
s_cmp_ge_u32 s48, 157696
s_cselect_b32 s48, 0, s48
s_add_u32 m0, s48, s47
s_nop 0
buffer_load_dwordx4 v10, s[32:35], s43 offen offset:0 lds
buffer_load_dwordx4 v11, s[32:35], s43 offen offset:1024 lds
s_add_u32 m0, s48, s46
s_nop 0
buffer_load_dwordx4 v4, s[32:35], s41 offen offset:0 lds
buffer_load_dwordx4 v5, s[32:35], s41 offen offset:1024 lds
buffer_load_dwordx4 v6, s[32:35], s41 offen offset:2048 lds
buffer_load_dwordx4 v7, s[32:35], s41 offen offset:3072 lds
s_add_u32 s41, s41, 2048
s_add_u32 s43, s43, 2048
s_add_u32 s48, s48, 22528
s_cmp_ge_u32 s48, 157696
s_cselect_b32 s48, 0, s48
s_waitcnt vmcnt(12)
s_barrier
s_add_u32 m0, s48, s47
s_nop 0
buffer_load_dwordx4 v10, s[32:35], s43 offen offset:0 lds
buffer_load_dwordx4 v11, s[32:35], s43 offen offset:1024 lds
s_add_u32 m0, s48, s46
s_nop 0
buffer_load_dwordx4 v4, s[32:35], s41 offen offset:0 lds
buffer_load_dwordx4 v5, s[32:35], s41 offen offset:1024 lds
buffer_load_dwordx4 v6, s[32:35], s41 offen offset:2048 lds
buffer_load_dwordx4 v7, s[32:35], s41 offen offset:3072 lds
s_add_u32 s41, s41, 2048
s_add_u32 s43, s43, 2048
s_add_u32 s48, s48, 22528
s_cmp_ge_u32 s48, 157696
s_cselect_b32 s48, 0, s48
s_add_u32 m0, s48, s47
s_nop 0
buffer_load_dwordx4 v10, s[32:35], s43 offen offset:0 lds
buffer_load_dwordx4 v11, s[32:35], s43 offen offset:1024 lds
s_add_u32 m0, s48, s46
s_nop 0
buffer_load_dwordx4 v4, s[32:35], s41 offen offset:0 lds
buffer_load_dwordx4 v5, s[32:35], s41 offen offset:1024 lds
buffer_load_dwordx4 v6, s[32:35], s41 offen offset:2048 lds
buffer_load_dwordx4 v7, s[32:35], s41 offen offset:3072 lds
s_add_u32 s41, s41, 2048
s_add_u32 s43, s43, 2048
s_add_u32 s48, s48, 22528
s_cmp_ge_u32 s48, 157696
s_cselect_b32 s48, 0, s48
s_waitcnt vmcnt(18)
s_barrier
s_add_u32 m0, s48, s47
s_nop 0
buffer_load_dwordx4 v10, s[32:35], s43 offen offset:0 lds
buffer_load_dwordx4 v11, s[32:35], s43 offen offset:1024 lds
s_add_u32 m0, s48, s46
s_nop 0
buffer_load_dwordx4 v4, s[32:35], s41 offen offset:0 lds
buffer_load_dwordx4 v5, s[32:35], s41 offen offset:1024 lds
buffer_load_dwordx4 v6, s[32:35], s41 offen offset:2048 lds
buffer_load_dwordx4 v7, s[32:35], s41 offen offset:3072 lds
s_add_u32 s41, s41, 2048
s_add_u32 s43, s43, 2048
s_add_u32 s48, s48, 22528
s_cmp_ge_u32 s48, 157696
s_cselect_b32 s48, 0, s48
s_add_u32 m0, s48, s47
s_nop 0
buffer_load_dwordx4 v10, s[32:35], s43 offen offset:0 lds
buffer_load_dwordx4 v11, s[32:35], s43 offen offset:1024 lds
s_add_u32 m0, s48, s46
s_nop 0
buffer_load_dwordx4 v4, s[32:35], s41 offen offset:0 lds
buffer_load_dwordx4 v5, s[32:35], s41 offen offset:1024 lds
buffer_load_dwordx4 v6, s[32:35], s41 offen offset:2048 lds
buffer_load_dwordx4 v7, s[32:35], s41 offen offset:3072 lds
s_add_u32 s41, s41, 2048
s_add_u32 s43, s43, 2048
s_add_u32 s48, s48, 22528
s_cmp_ge_u32 s48, 157696
s_cselect_b32 s48, 0, s48
s_waitcnt vmcnt(24)
s_barrier
s_add_u32 m0, s48, s47
s_nop 0
buffer_load_dwordx4 v10, s[32:35], s43 offen offset:0 lds
buffer_load_dwordx4 v11, s[32:35], s43 offen offset:1024 lds
s_add_u32 m0, s48, s46
s_nop 0
buffer_load_dwordx4 v4, s[32:35], s41 offen offset:0 lds
buffer_load_dwordx4 v5, s[32:35], s41 offen offset:1024 lds
buffer_load_dwordx4 v6, s[32:35], s41 offen offset:2048 lds
buffer_load_dwordx4 v7, s[32:35], s41 offen offset:3072 lds
s_add_u32 s41, s41, 2048
s_add_u32 s43, s43, 2048
s_add_u32 s48, s48, 22528
s_cmp_ge_u32 s48, 157696
s_cselect_b32 s48, 0, s48
s_add_u32 m0, s48, s47
s_nop 0
buffer_load_dwordx4 v10, s[32:35], s43 offen offset:0 lds
buffer_load_dwordx4 v11, s[32:35], s43 offen offset:1024 lds
s_add_u32 m0, s48, s46
s_nop 0
buffer_load_dwordx4 v4, s[32:35], s41 offen offset:0 lds
buffer_load_dwordx4 v5, s[32:35], s41 offen offset:1024 lds
buffer_load_dwordx4 v6, s[32:35], s41 offen offset:2048 lds
buffer_load_dwordx4 v7, s[32:35], s41 offen offset:3072 lds
s_add_u32 s41, s41, 2048
s_add_u32 s43, s43, 2048
s_add_u32 s48, s48, 22528
s_cmp_ge_u32 s48, 157696
s_cselect_b32 s48, 0, s48
s_mov_b32 s49, 2
Lp3ld_22:
s_waitcnt vmcnt(30)
s_barrier
s_add_u32 m0, s48, s47
s_nop 0
buffer_load_dwordx4 v10, s[32:35], s43 offen offset:0 lds
buffer_load_dwordx4 v11, s[32:35], s43 offen offset:1024 lds
s_add_u32 m0, s48, s46
s_nop 0
buffer_load_dwordx4 v4, s[32:35], s41 offen offset:0 lds
buffer_load_dwordx4 v5, s[32:35], s41 offen offset:1024 lds
buffer_load_dwordx4 v6, s[32:35], s41 offen offset:2048 lds
buffer_load_dwordx4 v7, s[32:35], s41 offen offset:3072 lds
s_add_u32 s41, s41, 2048
s_add_u32 s43, s43, 2048
s_add_u32 s48, s48, 22528
s_cmp_ge_u32 s48, 157696
s_cselect_b32 s48, 0, s48
s_add_u32 s49, s49, 1
s_cmp_lt_u32 s49, 13
s_cbranch_scc1 Lp3ld_22
s_waitcnt vmcnt(30)
s_barrier
s_cmp_lg_u32 s40, 0
s_cbranch_scc1 Lp3x_23
s_add_u32 m0, s48, s46
s_nop 0
buffer_load_dwordx4 v4, s[32:35], s41 offen offset:0 lds
buffer_load_dwordx4 v5, s[32:35], s41 offen offset:1024 lds
buffer_load_dwordx4 v6, s[32:35], s41 offen offset:2048 lds
buffer_load_dwordx4 v7, s[32:35], s41 offen offset:3072 lds
s_add_u32 s41, s41, 2048
s_add_u32 s43, s43, 2048
s_add_u32 s48, s48, 22528
s_cmp_ge_u32 s48, 157696
s_cselect_b32 s48, 0, s48
Lp3x_23:
s_waitcnt vmcnt(24)
s_barrier
s_waitcnt vmcnt(18)
s_barrier
s_waitcnt vmcnt(12)
s_barrier
s_waitcnt vmcnt(6)
s_barrier
s_waitcnt vmcnt(0)
s_barrier
s_barrier
s_barrier
s_branch Lp3_exit
Lp3_ld1:
v_and_b32 v1, 63, v0
v_lshlrev_b32 v2, 4, v1
v_add_u32 v4, 167936, v2
v_add_u32 v5, 208896, v2
v_add_u32 v6, 249856, v2
s_and_b32 s40, s26, 1
s_mul_i32 s41, s30, 41984
s_lshl_b32 s42, s40, 10
s_add_u32 s41, s41, s42
s_add_u32 s41, s41, 6225920
v_add_u32 v10, 0, v2
v_add_u32 v11, 39936, v2
s_lshl_b32 s43, s29, 2
s_lshr_b32 s44, s26, 1
s_lshl_b32 s45, s44, 1
s_add_u32 s43, s43, s45
s_mul_i32 s43, s43, 40960
s_add_u32 s43, s43, s42
s_add_u32 s43, s43, 13041664
s_mul_i32 s46, s40, 7168
s_add_u32 s46, s46, 4096
s_lshl_b32 s47, s40, 12
s_lshl_b32 s45, s45, 10
s_add_u32 s47, s47, s45
s_add_u32 s47, s47, 14336
s_mov_b32 s48, 0
s_add_u32 m0, s48, s47
s_nop 0
buffer_load_dwordx4 v10, s[32:35], s43 offen offset:0 lds
buffer_load_dwordx4 v11, s[32:35], s43 offen offset:1024 lds
s_add_u32 m0, s48, s46
s_nop 0
buffer_load_dwordx4 v4, s[32:35], s41 offen offset:0 lds
buffer_load_dwordx4 v5, s[32:35], s41 offen offset:1024 lds
buffer_load_dwordx4 v6, s[32:35], s41 offen offset:2048 lds
s_add_u32 s41, s41, 2048
s_add_u32 s43, s43, 2048
s_add_u32 s48, s48, 22528
s_cmp_ge_u32 s48, 157696
s_cselect_b32 s48, 0, s48
s_add_u32 m0, s48, s47
s_nop 0
buffer_load_dwordx4 v10, s[32:35], s43 offen offset:0 lds
buffer_load_dwordx4 v11, s[32:35], s43 offen offset:1024 lds
s_add_u32 m0, s48, s46
s_nop 0
buffer_load_dwordx4 v4, s[32:35], s41 offen offset:0 lds
buffer_load_dwordx4 v5, s[32:35], s41 offen offset:1024 lds
buffer_load_dwordx4 v6, s[32:35], s41 offen offset:2048 lds
s_add_u32 s41, s41, 2048
s_add_u32 s43, s43, 2048
s_add_u32 s48, s48, 22528
s_cmp_ge_u32 s48, 157696
s_cselect_b32 s48, 0, s48
s_add_u32 m0, s48, s47
s_nop 0
buffer_load_dwordx4 v10, s[32:35], s43 offen offset:0 lds
buffer_load_dwordx4 v11, s[32:35], s43 offen offset:1024 lds
s_add_u32 m0, s48, s46
s_nop 0
buffer_load_dwordx4 v4, s[32:35], s41 offen offset:0 lds
buffer_load_dwordx4 v5, s[32:35], s41 offen offset:1024 lds
buffer_load_dwordx4 v6, s[32:35], s41 offen offset:2048 lds
s_add_u32 s41, s41, 2048
s_add_u32 s43, s43, 2048
s_add_u32 s48, s48, 22528
s_cmp_ge_u32 s48, 157696
s_cselect_b32 s48, 0, s48
s_waitcnt vmcnt(10)
s_barrier
s_add_u32 m0, s48, s47
s_nop 0
buffer_load_dwordx4 v10, s[32:35], s43 offen offset:0 lds
buffer_load_dwordx4 v11, s[32:35], s43 offen offset:1024 lds
s_add_u32 m0, s48, s46
s_nop 0
buffer_load_dwordx4 v4, s[32:35], s41 offen offset:0 lds
buffer_load_dwordx4 v5, s[32:35], s41 offen offset:1024 lds
buffer_load_dwordx4 v6, s[32:35], s41 offen offset:2048 lds
s_add_u32 s41, s41, 2048
s_add_u32 s43, s43, 2048
s_add_u32 s48, s48, 22528
s_cmp_ge_u32 s48, 157696
s_cselect_b32 s48, 0, s48
s_add_u32 m0, s48, s47
s_nop 0
buffer_load_dwordx4 v10, s[32:35], s43 offen offset:0 lds
buffer_load_dwordx4 v11, s[32:35], s43 offen offset:1024 lds
s_add_u32 m0, s48, s46
s_nop 0
buffer_load_dwordx4 v4, s[32:35], s41 offen offset:0 lds
buffer_load_dwordx4 v5, s[32:35], s41 offen offset:1024 lds
buffer_load_dwordx4 v6, s[32:35], s41 offen offset:2048 lds
s_add_u32 s41, s41, 2048
s_add_u32 s43, s43, 2048
s_add_u32 s48, s48, 22528
s_cmp_ge_u32 s48, 157696
s_cselect_b32 s48, 0, s48
s_waitcnt vmcnt(15)
s_barrier
s_add_u32 m0, s48, s47
s_nop 0
buffer_load_dwordx4 v10, s[32:35], s43 offen offset:0 lds
buffer_load_dwordx4 v11, s[32:35], s43 offen offset:1024 lds
s_add_u32 m0, s48, s46
s_nop 0
buffer_load_dwordx4 v4, s[32:35], s41 offen offset:0 lds
buffer_load_dwordx4 v5, s[32:35], s41 offen offset:1024 lds
buffer_load_dwordx4 v6, s[32:35], s41 offen offset:2048 lds
s_add_u32 s41, s41, 2048
s_add_u32 s43, s43, 2048
s_add_u32 s48, s48, 22528
s_cmp_ge_u32 s48, 157696
s_cselect_b32 s48, 0, s48
s_add_u32 m0, s48, s47
s_nop 0
buffer_load_dwordx4 v10, s[32:35], s43 offen offset:0 lds
buffer_load_dwordx4 v11, s[32:35], s43 offen offset:1024 lds
s_add_u32 m0, s48, s46
s_nop 0
buffer_load_dwordx4 v4, s[32:35], s41 offen offset:0 lds
buffer_load_dwordx4 v5, s[32:35], s41 offen offset:1024 lds
buffer_load_dwordx4 v6, s[32:35], s41 offen offset:2048 lds
s_add_u32 s41, s41, 2048
s_add_u32 s43, s43, 2048
s_add_u32 s48, s48, 22528
s_cmp_ge_u32 s48, 157696
s_cselect_b32 s48, 0, s48
s_waitcnt vmcnt(20)
s_barrier
s_add_u32 m0, s48, s47
s_nop 0
buffer_load_dwordx4 v10, s[32:35], s43 offen offset:0 lds
buffer_load_dwordx4 v11, s[32:35], s43 offen offset:1024 lds
s_add_u32 m0, s48, s46
s_nop 0
buffer_load_dwordx4 v4, s[32:35], s41 offen offset:0 lds
buffer_load_dwordx4 v5, s[32:35], s41 offen offset:1024 lds
buffer_load_dwordx4 v6, s[32:35], s41 offen offset:2048 lds
s_add_u32 s41, s41, 2048
s_add_u32 s43, s43, 2048
s_add_u32 s48, s48, 22528
s_cmp_ge_u32 s48, 157696
s_cselect_b32 s48, 0, s48
s_add_u32 m0, s48, s47
s_nop 0
buffer_load_dwordx4 v10, s[32:35], s43 offen offset:0 lds
buffer_load_dwordx4 v11, s[32:35], s43 offen offset:1024 lds
s_add_u32 m0, s48, s46
s_nop 0
buffer_load_dwordx4 v4, s[32:35], s41 offen offset:0 lds
buffer_load_dwordx4 v5, s[32:35], s41 offen offset:1024 lds
buffer_load_dwordx4 v6, s[32:35], s41 offen offset:2048 lds
s_add_u32 s41, s41, 2048
s_add_u32 s43, s43, 2048
s_add_u32 s48, s48, 22528
s_cmp_ge_u32 s48, 157696
s_cselect_b32 s48, 0, s48
s_mov_b32 s49, 2
Lp3ld_24:
s_waitcnt vmcnt(25)
s_barrier
s_add_u32 m0, s48, s47
s_nop 0
buffer_load_dwordx4 v10, s[32:35], s43 offen offset:0 lds
buffer_load_dwordx4 v11, s[32:35], s43 offen offset:1024 lds
s_add_u32 m0, s48, s46
s_nop 0
buffer_load_dwordx4 v4, s[32:35], s41 offen offset:0 lds
buffer_load_dwordx4 v5, s[32:35], s41 offen offset:1024 lds
buffer_load_dwordx4 v6, s[32:35], s41 offen offset:2048 lds
s_add_u32 s41, s41, 2048
s_add_u32 s43, s43, 2048
s_add_u32 s48, s48, 22528
s_cmp_ge_u32 s48, 157696
s_cselect_b32 s48, 0, s48
s_add_u32 s49, s49, 1
s_cmp_lt_u32 s49, 13
s_cbranch_scc1 Lp3ld_24
s_waitcnt vmcnt(25)
s_barrier
s_cmp_lg_u32 s40, 0
s_cbranch_scc1 Lp3x_25
s_add_u32 m0, s48, s46
s_nop 0
buffer_load_dwordx4 v4, s[32:35], s41 offen offset:0 lds
buffer_load_dwordx4 v5, s[32:35], s41 offen offset:1024 lds
buffer_load_dwordx4 v6, s[32:35], s41 offen offset:2048 lds
s_add_u32 s41, s41, 2048
s_add_u32 s43, s43, 2048
s_add_u32 s48, s48, 22528
s_cmp_ge_u32 s48, 157696
s_cselect_b32 s48, 0, s48
Lp3x_25:
s_waitcnt vmcnt(20)
s_barrier
s_waitcnt vmcnt(15)
s_barrier
s_waitcnt vmcnt(10)
s_barrier
s_waitcnt vmcnt(5)
s_barrier
s_waitcnt vmcnt(0)
s_barrier
s_barrier
s_barrier
s_branch Lp3_exit
Lp3_cons:
v_and_b32 v1, 63, v0
s_getpc_b64 s[70:71]
Lpc_26:
s_sub_u32 s70, s70, Lpc_26-p3_kernel
s_subb_u32 s71, s71, 0
v_lshlrev_b32 v3, 7, v1
v_min_u32 v3, Lp3_exit-p3_kernel-4, v3
global_load_dword v255, v3, s[70:71]
v_and_b32 v1, 63, v0
v_lshlrev_b32 v2, 4, v1
v_and_b32 v3, 31, v1
s_lshl_b32 s40, s29, 7
s_lshl_b32 s41, s26, 5
s_add_u32 s40, s40, s41
s_lshl_b32 s40, s40, 5
s_add_u32 s40, s40, 15663104
v_lshlrev_b32 v6, 5, v3
buffer_load_dwordx4 v[200:203], v6, s[32:35], s40 offen
buffer_load_dwordx4 v[204:207], v6, s[32:35], s40 offen offset:16
v_mov_b32 v4, v2
s_lshl_b32 s41, s26, 10
s_add_u32 s41, s41, 14336
v_add_u32 v5, s41, v2
v_mov_b32 v16, 0
v_mov_b32 v17, 0
v_mov_b32 v18, 0
v_mov_b32 v19, 0
v_mov_b32 v20, 0
v_mov_b32 v21, 0
v_mov_b32 v22, 0
v_mov_b32 v23, 0
v_mov_b32 v24, 0
v_mov_b32 v25, 0
v_mov_b32 v26, 0
v_mov_b32 v27, 0
v_mov_b32 v28, 0
v_mov_b32 v29, 0
v_mov_b32 v30, 0
v_mov_b32 v31, 0
v_mov_b32 v32, 0
v_mov_b32 v33, 0
v_mov_b32 v34, 0
v_mov_b32 v35, 0
v_mov_b32 v36, 0
v_mov_b32 v37, 0
v_mov_b32 v38, 0
v_mov_b32 v39, 0
v_mov_b32 v40, 0
v_mov_b32 v41, 0
v_mov_b32 v42, 0
v_mov_b32 v43, 0
v_mov_b32 v44, 0
v_mov_b32 v45, 0
v_mov_b32 v46, 0
v_mov_b32 v47, 0
v_mov_b32 v48, 0
v_mov_b32 v49, 0
v_mov_b32 v50, 0
v_mov_b32 v51, 0
v_mov_b32 v52, 0
v_mov_b32 v53, 0
v_mov_b32 v54, 0
v_mov_b32 v55, 0
v_mov_b32 v56, 0
v_mov_b32 v57, 0
v_mov_b32 v58, 0
v_mov_b32 v59, 0
v_mov_b32 v60, 0
v_mov_b32 v61, 0
v_mov_b32 v62, 0
v_mov_b32 v63, 0
v_mov_b32 v64, 0
v_mov_b32 v65, 0
v_mov_b32 v66, 0
v_mov_b32 v67, 0
v_mov_b32 v68, 0
v_mov_b32 v69, 0
v_mov_b32 v70, 0
v_mov_b32 v71, 0
v_mov_b32 v72, 0
v_mov_b32 v73, 0
v_mov_b32 v74, 0
v_mov_b32 v75, 0
v_mov_b32 v76, 0
v_mov_b32 v77, 0
v_mov_b32 v78, 0
v_mov_b32 v79, 0
v_mov_b32 v80, 0
v_mov_b32 v81, 0
v_mov_b32 v82, 0
v_mov_b32 v83, 0
v_mov_b32 v84, 0
v_mov_b32 v85, 0
v_mov_b32 v86, 0
v_mov_b32 v87, 0
v_mov_b32 v88, 0
v_mov_b32 v89, 0
v_mov_b32 v90, 0
v_mov_b32 v91, 0
v_mov_b32 v92, 0
v_mov_b32 v93, 0
v_mov_b32 v94, 0
v_mov_b32 v95, 0
v_mov_b32 v96, 0
v_mov_b32 v97, 0
v_mov_b32 v98, 0
v_mov_b32 v99, 0
v_mov_b32 v100, 0
v_mov_b32 v101, 0
v_mov_b32 v102, 0
v_mov_b32 v103, 0
v_mov_b32 v104, 0
v_mov_b32 v105, 0
v_mov_b32 v106, 0
v_mov_b32 v107, 0
v_mov_b32 v108, 0
v_mov_b32 v109, 0
v_mov_b32 v110, 0
v_mov_b32 v111, 0
v_mov_b32 v112, 0
v_mov_b32 v113, 0
v_mov_b32 v114, 0
v_mov_b32 v115, 0
v_mov_b32 v116, 0
v_mov_b32 v117, 0
v_mov_b32 v118, 0
v_mov_b32 v119, 0
v_mov_b32 v120, 0
v_mov_b32 v121, 0
v_mov_b32 v122, 0
v_mov_b32 v123, 0
v_mov_b32 v124, 0
v_mov_b32 v125, 0
v_mov_b32 v126, 0
v_mov_b32 v127, 0
s_mov_b32 s42, 0
s_mov_b32 s44, 22528
s_mov_b32 s45, 4294832128
s_barrier
ds_read_b128 v[184:187], v5 offset:0
ds_read_b128 v[128:131], v4 offset:0
ds_read_b128 v[132:135], v4 offset:1024
ds_read_b128 v[136:139], v4 offset:2048
ds_read_b128 v[140:143], v4 offset:3072
ds_read_b128 v[144:147], v4 offset:4096
ds_read_b128 v[148:151], v4 offset:5120
ds_read_b128 v[152:155], v4 offset:6144
s_waitcnt vmcnt(0)
v_add_f32 v200, v200, v202
v_add_f32 v201, v201, v203
v_add_f32 v204, v204, v206
v_add_f32 v205, v205, v207
v_add_f32 v200, v200, v204
v_add_f32 v201, v201, v205
s_mov_b32 s46, 0x3acccccd
v_mul_f32 v200, s46, v200
v_mul_f32 v201, s46, v201
v_fma_f32 v201, -v200, v200, v201
v_max_f32 v201, 0, v201
v_add_f32 v201, 0x3727c5ac, v201
v_rsq_f32 v208, v201
v_sub_f32 v200, 0, v200
v_cvt_pk_bf16_f32 v202, v200, v200
v_lshlrev_b32 v203, 16, v202
v_sub_f32 v203, v200, v203
v_cvt_pk_bf16_f32 v203, v203, v203
v_cmp_gt_u32 vcc, 32, v1
s_nop 1
v_cndmask_b32 v192, 0, v202, vcc
v_cndmask_b32 v193, 0, v203, vcc
v_mov_b32 v194, 0
v_mov_b32 v195, 0
s_waitcnt lgkmcnt(0)
s_mov_b32 s47, 0
Lp3main_27:
v_mfma_f32_32x32x16_bf16 v[16:31], v[128:131], v[184:187], v[16:31]
ds_read_b128 v[188:191], v5 offset:4096
ds_read_b128 v[156:159], v4 offset:7168
v_mfma_f32_32x32x16_bf16 v[32:47], v[132:135], v[184:187], v[32:47]
ds_read_b128 v[160:163], v4 offset:8192
ds_read_b128 v[164:167], v4 offset:9216
v_mfma_f32_32x32x16_bf16 v[48:63], v[136:139], v[184:187], v[48:63]
ds_read_b128 v[168:171], v4 offset:10240
ds_read_b128 v[172:175], v4 offset:11264
v_mfma_f32_32x32x16_bf16 v[64:79], v[140:143], v[184:187], v[64:79]
ds_read_b128 v[176:179], v4 offset:12288
ds_read_b128 v[180:183], v4 offset:13312
v_mfma_f32_32x32x16_bf16 v[80:95], v[144:147], v[184:187], v[80:95]
v_mfma_f32_32x32x16_bf16 v[96:111], v[148:151], v[184:187], v[96:111]
v_mfma_f32_32x32x16_bf16 v[112:127], v[152:155], v[184:187], v[112:127]
s_add_u32 s42, s42, 22528
s_cmp_ge_u32 s42, 157696
s_cselect_b32 s43, s45, s44
s_cselect_b32 s42, 0, s42
v_add_u32 v4, s43, v4
v_add_u32 v5, s43, v5
s_waitcnt lgkmcnt(0)
s_barrier
v_mfma_f32_32x32x16_bf16 v[16:31], v[156:159], v[188:191], v[16:31]
ds_read_b128 v[184:187], v5 offset:0
ds_read_b128 v[128:131], v4 offset:0
v_mfma_f32_32x32x16_bf16 v[32:47], v[160:163], v[188:191], v[32:47]
ds_read_b128 v[132:135], v4 offset:1024
ds_read_b128 v[136:139], v4 offset:2048
v_mfma_f32_32x32x16_bf16 v[48:63], v[164:167], v[188:191], v[48:63]
ds_read_b128 v[140:143], v4 offset:3072
ds_read_b128 v[144:147], v4 offset:4096
v_mfma_f32_32x32x16_bf16 v[64:79], v[168:171], v[188:191], v[64:79]
ds_read_b128 v[148:151], v4 offset:5120
ds_read_b128 v[152:155], v4 offset:6144
v_mfma_f32_32x32x16_bf16 v[80:95], v[172:175], v[188:191], v[80:95]
v_mfma_f32_32x32x16_bf16 v[96:111], v[176:179], v[188:191], v[96:111]
v_mfma_f32_32x32x16_bf16 v[112:127], v[180:183], v[188:191], v[112:127]
s_waitcnt lgkmcnt(0)
s_add_u32 s47, s47, 1
s_cmp_lt_u32 s47, 20
s_cbranch_scc1 Lp3main_27
v_mfma_f32_32x32x16_bf16 v[16:31], v[128:131], v[192:195], v[16:31]
v_mfma_f32_32x32x16_bf16 v[32:47], v[132:135], v[192:195], v[32:47]
v_mfma_f32_32x32x16_bf16 v[48:63], v[136:139], v[192:195], v[48:63]
v_mfma_f32_32x32x16_bf16 v[64:79], v[140:143], v[192:195], v[64:79]
v_mfma_f32_32x32x16_bf16 v[80:95], v[144:147], v[192:195], v[80:95]
v_mfma_f32_32x32x16_bf16 v[96:111], v[148:151], v[192:195], v[96:111]
v_mfma_f32_32x32x16_bf16 v[112:127], v[152:155], v[192:195], v[112:127]
s_barrier
v_and_b32 v3, 31, v1
v_lshrrev_b32 v6, 4, v3
v_mul_u32_u24 v6, 55296, v6
v_and_b32 v7, 15, v3
v_lshrrev_b32 v8, 5, v1
v_lshlrev_b32 v8, 4, v8
v_add_u32 v7, v7, v8
v_lshlrev_b32 v7, 4, v7
v_add_u32 v6, v6, v7
s_lshl_b32 s40, s29, 3
s_lshl_b32 s41, s26, 1
s_add_u32 s40, s40, s41
s_mul_i32 s40, s40, 55296
s_add_u32 s40, s40, 15728640
s_lshl_b32 s41, s30, 9
s_add_u32 s40, s40, s41
s_mov_b32 s50, 0xc0135761
s_mov_b32 s51, 0xc0135761
s_mov_b32 s52, 0xbdd2d3e8
s_mov_b32 s53, 0xbdd2d3e8
v_mov_b32 v210, s50
v_mov_b32 v211, s51
s_nop 3
v_pk_mul_f32 v[16:17], v[16:17], v[208:209] op_sel_hi:[1,0]
v_pk_mul_f32 v[18:19], v[18:19], v[208:209] op_sel_hi:[1,0]
v_pk_mul_f32 v[20:21], v[20:21], v[208:209] op_sel_hi:[1,0]
v_pk_mul_f32 v[22:23], v[22:23], v[208:209] op_sel_hi:[1,0]
v_pk_mul_f32 v[24:25], v[24:25], v[208:209] op_sel_hi:[1,0]
v_pk_mul_f32 v[26:27], v[26:27], v[208:209] op_sel_hi:[1,0]
v_pk_mul_f32 v[28:29], v[28:29], v[208:209] op_sel_hi:[1,0]
v_pk_mul_f32 v[30:31], v[30:31], v[208:209] op_sel_hi:[1,0]
v_pk_mul_f32 v[128:129], v[16:17], v[16:17]
v_pk_fma_f32 v[128:129], v[128:129], s[52:53], v[210:211]
v_pk_mul_f32 v[128:129], v[128:129], v[16:17]
v_pk_mul_f32 v[130:131], v[18:19], v[18:19]
v_pk_fma_f32 v[130:131], v[130:131], s[52:53], v[210:211]
v_pk_mul_f32 v[130:131], v[130:131], v[18:19]
v_pk_mul_f32 v[132:133], v[20:21], v[20:21]
v_pk_fma_f32 v[132:133], v[132:133], s[52:53], v[210:211]
v_pk_mul_f32 v[132:133], v[132:133], v[20:21]
v_pk_mul_f32 v[134:135], v[22:23], v[22:23]
v_pk_fma_f32 v[134:135], v[134:135], s[52:53], v[210:211]
v_pk_mul_f32 v[134:135], v[134:135], v[22:23]
v_exp_f32 v128, v128
v_exp_f32 v129, v129
v_exp_f32 v130, v130
v_exp_f32 v131, v131
v_exp_f32 v132, v132
v_exp_f32 v133, v133
v_exp_f32 v134, v134
v_exp_f32 v135, v135
v_pk_mul_f32 v[16:17], v[16:17], v[24:25]
v_pk_mul_f32 v[18:19], v[18:19], v[26:27]
v_pk_mul_f32 v[20:21], v[20:21], v[28:29]
v_pk_mul_f32 v[22:23], v[22:23], v[30:31]
v_pk_add_f32 v[128:129], v[128:129], 1.0 op_sel_hi:[1,0]
v_pk_add_f32 v[130:131], v[130:131], 1.0 op_sel_hi:[1,0]
v_pk_add_f32 v[132:133], v[132:133], 1.0 op_sel_hi:[1,0]
v_pk_add_f32 v[134:135], v[134:135], 1.0 op_sel_hi:[1,0]
v_rcp_f32 v128, v128
v_rcp_f32 v129, v129
v_rcp_f32 v130, v130
v_rcp_f32 v131, v131
v_rcp_f32 v132, v132
v_rcp_f32 v133, v133
v_rcp_f32 v134, v134
v_rcp_f32 v135, v135
s_nop 0
v_pk_mul_f32 v[16:17], v[16:17], v[128:129]
v_pk_mul_f32 v[18:19], v[18:19], v[130:131]
v_pk_mul_f32 v[20:21], v[20:21], v[132:133]
v_pk_mul_f32 v[22:23], v[22:23], v[134:135]
v_cvt_pk_bf16_f32 v136, v16, v17
v_cvt_pk_bf16_f32 v137, v18, v19
v_cvt_pk_bf16_f32 v138, v20, v21
v_cvt_pk_bf16_f32 v139, v22, v23
buffer_store_dwordx4 v[136:139], v6, s[32:35], s40 offen sc0 sc1
s_add_u32 s40, s40, 512
s_nop 1
v_pk_mul_f32 v[32:33], v[32:33], v[208:209] op_sel_hi:[1,0]
v_pk_mul_f32 v[34:35], v[34:35], v[208:209] op_sel_hi:[1,0]
v_pk_mul_f32 v[36:37], v[36:37], v[208:209] op_sel_hi:[1,0]
v_pk_mul_f32 v[38:39], v[38:39], v[208:209] op_sel_hi:[1,0]
v_pk_mul_f32 v[40:41], v[40:41], v[208:209] op_sel_hi:[1,0]
v_pk_mul_f32 v[42:43], v[42:43], v[208:209] op_sel_hi:[1,0]
v_pk_mul_f32 v[44:45], v[44:45], v[208:209] op_sel_hi:[1,0]
v_pk_mul_f32 v[46:47], v[46:47], v[208:209] op_sel_hi:[1,0]
v_pk_mul_f32 v[128:129], v[32:33], v[32:33]
v_pk_fma_f32 v[128:129], v[128:129], s[52:53], v[210:211]
v_pk_mul_f32 v[128:129], v[128:129], v[32:33]
v_pk_mul_f32 v[130:131], v[34:35], v[34:35]
v_pk_fma_f32 v[130:131], v[130:131], s[52:53], v[210:211]
v_pk_mul_f32 v[130:131], v[130:131], v[34:35]
v_pk_mul_f32 v[132:133], v[36:37], v[36:37]
v_pk_fma_f32 v[132:133], v[132:133], s[52:53], v[210:211]
v_pk_mul_f32 v[132:133], v[132:133], v[36:37]
v_pk_mul_f32 v[134:135], v[38:39], v[38:39]
v_pk_fma_f32 v[134:135], v[134:135], s[52:53], v[210:211]
v_pk_mul_f32 v[134:135], v[134:135], v[38:39]
v_exp_f32 v128, v128
v_exp_f32 v129, v129
v_exp_f32 v130, v130
v_exp_f32 v131, v131
v_exp_f32 v132, v132
v_exp_f32 v133, v133
v_exp_f32 v134, v134
v_exp_f32 v135, v135
v_pk_mul_f32 v[32:33], v[32:33], v[40:41]
v_pk_mul_f32 v[34:35], v[34:35], v[42:43]
v_pk_mul_f32 v[36:37], v[36:37], v[44:45]
v_pk_mul_f32 v[38:39], v[38:39], v[46:47]
v_pk_add_f32 v[128:129], v[128:129], 1.0 op_sel_hi:[1,0]
v_pk_add_f32 v[130:131], v[130:131], 1.0 op_sel_hi:[1,0]
v_pk_add_f32 v[132:133], v[132:133], 1.0 op_sel_hi:[1,0]
v_pk_add_f32 v[134:135], v[134:135], 1.0 op_sel_hi:[1,0]
v_rcp_f32 v128, v128
v_rcp_f32 v129, v129
v_rcp_f32 v130, v130
v_rcp_f32 v131, v131
v_rcp_f32 v132, v132
v_rcp_f32 v133, v133
v_rcp_f32 v134, v134
v_rcp_f32 v135, v135
s_nop 0
v_pk_mul_f32 v[32:33], v[32:33], v[128:129]
v_pk_mul_f32 v[34:35], v[34:35], v[130:131]
v_pk_mul_f32 v[36:37], v[36:37], v[132:133]
v_pk_mul_f32 v[38:39], v[38:39], v[134:135]
v_cvt_pk_bf16_f32 v136, v32, v33
v_cvt_pk_bf16_f32 v137, v34, v35
v_cvt_pk_bf16_f32 v138, v36, v37
v_cvt_pk_bf16_f32 v139, v38, v39
buffer_store_dwordx4 v[136:139], v6, s[32:35], s40 offen sc0 sc1
s_add_u32 s40, s40, 512
s_nop 1
v_pk_mul_f32 v[48:49], v[48:49], v[208:209] op_sel_hi:[1,0]
v_pk_mul_f32 v[50:51], v[50:51], v[208:209] op_sel_hi:[1,0]
v_pk_mul_f32 v[52:53], v[52:53], v[208:209] op_sel_hi:[1,0]
v_pk_mul_f32 v[54:55], v[54:55], v[208:209] op_sel_hi:[1,0]
v_pk_mul_f32 v[56:57], v[56:57], v[208:209] op_sel_hi:[1,0]
v_pk_mul_f32 v[58:59], v[58:59], v[208:209] op_sel_hi:[1,0]
v_pk_mul_f32 v[60:61], v[60:61], v[208:209] op_sel_hi:[1,0]
v_pk_mul_f32 v[62:63], v[62:63], v[208:209] op_sel_hi:[1,0]
v_pk_mul_f32 v[128:129], v[48:49], v[48:49]
v_pk_fma_f32 v[128:129], v[128:129], s[52:53], v[210:211]
v_pk_mul_f32 v[128:129], v[128:129], v[48:49]
v_pk_mul_f32 v[130:131], v[50:51], v[50:51]
v_pk_fma_f32 v[130:131], v[130:131], s[52:53], v[210:211]
v_pk_mul_f32 v[130:131], v[130:131], v[50:51]
v_pk_mul_f32 v[132:133], v[52:53], v[52:53]
v_pk_fma_f32 v[132:133], v[132:133], s[52:53], v[210:211]
v_pk_mul_f32 v[132:133], v[132:133], v[52:53]
v_pk_mul_f32 v[134:135], v[54:55], v[54:55]
v_pk_fma_f32 v[134:135], v[134:135], s[52:53], v[210:211]
v_pk_mul_f32 v[134:135], v[134:135], v[54:55]
v_exp_f32 v128, v128
v_exp_f32 v129, v129
v_exp_f32 v130, v130
v_exp_f32 v131, v131
v_exp_f32 v132, v132
v_exp_f32 v133, v133
v_exp_f32 v134, v134
v_exp_f32 v135, v135
v_pk_mul_f32 v[48:49], v[48:49], v[56:57]
v_pk_mul_f32 v[50:51], v[50:51], v[58:59]
v_pk_mul_f32 v[52:53], v[52:53], v[60:61]
v_pk_mul_f32 v[54:55], v[54:55], v[62:63]
v_pk_add_f32 v[128:129], v[128:129], 1.0 op_sel_hi:[1,0]
v_pk_add_f32 v[130:131], v[130:131], 1.0 op_sel_hi:[1,0]
v_pk_add_f32 v[132:133], v[132:133], 1.0 op_sel_hi:[1,0]
v_pk_add_f32 v[134:135], v[134:135], 1.0 op_sel_hi:[1,0]
v_rcp_f32 v128, v128
v_rcp_f32 v129, v129
v_rcp_f32 v130, v130
v_rcp_f32 v131, v131
v_rcp_f32 v132, v132
v_rcp_f32 v133, v133
v_rcp_f32 v134, v134
v_rcp_f32 v135, v135
s_nop 0
v_pk_mul_f32 v[48:49], v[48:49], v[128:129]
v_pk_mul_f32 v[50:51], v[50:51], v[130:131]
v_pk_mul_f32 v[52:53], v[52:53], v[132:133]
v_pk_mul_f32 v[54:55], v[54:55], v[134:135]
v_cvt_pk_bf16_f32 v136, v48, v49
v_cvt_pk_bf16_f32 v137, v50, v51
v_cvt_pk_bf16_f32 v138, v52, v53
v_cvt_pk_bf16_f32 v139, v54, v55
buffer_store_dwordx4 v[136:139], v6, s[32:35], s40 offen sc0 sc1
s_add_u32 s40, s40, 512
s_nop 1
v_pk_mul_f32 v[64:65], v[64:65], v[208:209] op_sel_hi:[1,0]
v_pk_mul_f32 v[66:67], v[66:67], v[208:209] op_sel_hi:[1,0]
v_pk_mul_f32 v[68:69], v[68:69], v[208:209] op_sel_hi:[1,0]
v_pk_mul_f32 v[70:71], v[70:71], v[208:209] op_sel_hi:[1,0]
v_pk_mul_f32 v[72:73], v[72:73], v[208:209] op_sel_hi:[1,0]
v_pk_mul_f32 v[74:75], v[74:75], v[208:209] op_sel_hi:[1,0]
v_pk_mul_f32 v[76:77], v[76:77], v[208:209] op_sel_hi:[1,0]
v_pk_mul_f32 v[78:79], v[78:79], v[208:209] op_sel_hi:[1,0]
v_pk_mul_f32 v[128:129], v[64:65], v[64:65]
v_pk_fma_f32 v[128:129], v[128:129], s[52:53], v[210:211]
v_pk_mul_f32 v[128:129], v[128:129], v[64:65]
v_pk_mul_f32 v[130:131], v[66:67], v[66:67]
v_pk_fma_f32 v[130:131], v[130:131], s[52:53], v[210:211]
v_pk_mul_f32 v[130:131], v[130:131], v[66:67]
v_pk_mul_f32 v[132:133], v[68:69], v[68:69]
v_pk_fma_f32 v[132:133], v[132:133], s[52:53], v[210:211]
v_pk_mul_f32 v[132:133], v[132:133], v[68:69]
v_pk_mul_f32 v[134:135], v[70:71], v[70:71]
v_pk_fma_f32 v[134:135], v[134:135], s[52:53], v[210:211]
v_pk_mul_f32 v[134:135], v[134:135], v[70:71]
v_exp_f32 v128, v128
v_exp_f32 v129, v129
v_exp_f32 v130, v130
v_exp_f32 v131, v131
v_exp_f32 v132, v132
v_exp_f32 v133, v133
v_exp_f32 v134, v134
v_exp_f32 v135, v135
v_pk_mul_f32 v[64:65], v[64:65], v[72:73]
v_pk_mul_f32 v[66:67], v[66:67], v[74:75]
v_pk_mul_f32 v[68:69], v[68:69], v[76:77]
v_pk_mul_f32 v[70:71], v[70:71], v[78:79]
v_pk_add_f32 v[128:129], v[128:129], 1.0 op_sel_hi:[1,0]
v_pk_add_f32 v[130:131], v[130:131], 1.0 op_sel_hi:[1,0]
v_pk_add_f32 v[132:133], v[132:133], 1.0 op_sel_hi:[1,0]
v_pk_add_f32 v[134:135], v[134:135], 1.0 op_sel_hi:[1,0]
v_rcp_f32 v128, v128
v_rcp_f32 v129, v129
v_rcp_f32 v130, v130
v_rcp_f32 v131, v131
v_rcp_f32 v132, v132
v_rcp_f32 v133, v133
v_rcp_f32 v134, v134
v_rcp_f32 v135, v135
s_nop 0
v_pk_mul_f32 v[64:65], v[64:65], v[128:129]
v_pk_mul_f32 v[66:67], v[66:67], v[130:131]
v_pk_mul_f32 v[68:69], v[68:69], v[132:133]
v_pk_mul_f32 v[70:71], v[70:71], v[134:135]
v_cvt_pk_bf16_f32 v136, v64, v65
v_cvt_pk_bf16_f32 v137, v66, v67
v_cvt_pk_bf16_f32 v138, v68, v69
v_cvt_pk_bf16_f32 v139, v70, v71
buffer_store_dwordx4 v[136:139], v6, s[32:35], s40 offen sc0 sc1
s_add_u32 s40, s40, 512
s_nop 1
v_pk_mul_f32 v[80:81], v[80:81], v[208:209] op_sel_hi:[1,0]
v_pk_mul_f32 v[82:83], v[82:83], v[208:209] op_sel_hi:[1,0]
v_pk_mul_f32 v[84:85], v[84:85], v[208:209] op_sel_hi:[1,0]
v_pk_mul_f32 v[86:87], v[86:87], v[208:209] op_sel_hi:[1,0]
v_pk_mul_f32 v[88:89], v[88:89], v[208:209] op_sel_hi:[1,0]
v_pk_mul_f32 v[90:91], v[90:91], v[208:209] op_sel_hi:[1,0]
v_pk_mul_f32 v[92:93], v[92:93], v[208:209] op_sel_hi:[1,0]
v_pk_mul_f32 v[94:95], v[94:95], v[208:209] op_sel_hi:[1,0]
v_pk_mul_f32 v[128:129], v[80:81], v[80:81]
v_pk_fma_f32 v[128:129], v[128:129], s[52:53], v[210:211]
v_pk_mul_f32 v[128:129], v[128:129], v[80:81]
v_pk_mul_f32 v[130:131], v[82:83], v[82:83]
v_pk_fma_f32 v[130:131], v[130:131], s[52:53], v[210:211]
v_pk_mul_f32 v[130:131], v[130:131], v[82:83]
v_pk_mul_f32 v[132:133], v[84:85], v[84:85]
v_pk_fma_f32 v[132:133], v[132:133], s[52:53], v[210:211]
v_pk_mul_f32 v[132:133], v[132:133], v[84:85]
v_pk_mul_f32 v[134:135], v[86:87], v[86:87]
v_pk_fma_f32 v[134:135], v[134:135], s[52:53], v[210:211]
v_pk_mul_f32 v[134:135], v[134:135], v[86:87]
v_exp_f32 v128, v128
v_exp_f32 v129, v129
v_exp_f32 v130, v130
v_exp_f32 v131, v131
v_exp_f32 v132, v132
v_exp_f32 v133, v133
v_exp_f32 v134, v134
v_exp_f32 v135, v135
v_pk_mul_f32 v[80:81], v[80:81], v[88:89]
v_pk_mul_f32 v[82:83], v[82:83], v[90:91]
v_pk_mul_f32 v[84:85], v[84:85], v[92:93]
v_pk_mul_f32 v[86:87], v[86:87], v[94:95]
v_pk_add_f32 v[128:129], v[128:129], 1.0 op_sel_hi:[1,0]
v_pk_add_f32 v[130:131], v[130:131], 1.0 op_sel_hi:[1,0]
v_pk_add_f32 v[132:133], v[132:133], 1.0 op_sel_hi:[1,0]
v_pk_add_f32 v[134:135], v[134:135], 1.0 op_sel_hi:[1,0]
v_rcp_f32 v128, v128
v_rcp_f32 v129, v129
v_rcp_f32 v130, v130
v_rcp_f32 v131, v131
v_rcp_f32 v132, v132
v_rcp_f32 v133, v133
v_rcp_f32 v134, v134
v_rcp_f32 v135, v135
s_nop 0
v_pk_mul_f32 v[80:81], v[80:81], v[128:129]
v_pk_mul_f32 v[82:83], v[82:83], v[130:131]
v_pk_mul_f32 v[84:85], v[84:85], v[132:133]
v_pk_mul_f32 v[86:87], v[86:87], v[134:135]
v_cvt_pk_bf16_f32 v136, v80, v81
v_cvt_pk_bf16_f32 v137, v82, v83
v_cvt_pk_bf16_f32 v138, v84, v85
v_cvt_pk_bf16_f32 v139, v86, v87
buffer_store_dwordx4 v[136:139], v6, s[32:35], s40 offen sc0 sc1
s_add_u32 s40, s40, 512
s_nop 1
v_pk_mul_f32 v[96:97], v[96:97], v[208:209] op_sel_hi:[1,0]
v_pk_mul_f32 v[98:99], v[98:99], v[208:209] op_sel_hi:[1,0]
v_pk_mul_f32 v[100:101], v[100:101], v[208:209] op_sel_hi:[1,0]
v_pk_mul_f32 v[102:103], v[102:103], v[208:209] op_sel_hi:[1,0]
v_pk_mul_f32 v[104:105], v[104:105], v[208:209] op_sel_hi:[1,0]
v_pk_mul_f32 v[106:107], v[106:107], v[208:209] op_sel_hi:[1,0]
v_pk_mul_f32 v[108:109], v[108:109], v[208:209] op_sel_hi:[1,0]
v_pk_mul_f32 v[110:111], v[110:111], v[208:209] op_sel_hi:[1,0]
v_pk_mul_f32 v[128:129], v[96:97], v[96:97]
v_pk_fma_f32 v[128:129], v[128:129], s[52:53], v[210:211]
v_pk_mul_f32 v[128:129], v[128:129], v[96:97]
v_pk_mul_f32 v[130:131], v[98:99], v[98:99]
v_pk_fma_f32 v[130:131], v[130:131], s[52:53], v[210:211]
v_pk_mul_f32 v[130:131], v[130:131], v[98:99]
v_pk_mul_f32 v[132:133], v[100:101], v[100:101]
v_pk_fma_f32 v[132:133], v[132:133], s[52:53], v[210:211]
v_pk_mul_f32 v[132:133], v[132:133], v[100:101]
v_pk_mul_f32 v[134:135], v[102:103], v[102:103]
v_pk_fma_f32 v[134:135], v[134:135], s[52:53], v[210:211]
v_pk_mul_f32 v[134:135], v[134:135], v[102:103]
v_exp_f32 v128, v128
v_exp_f32 v129, v129
v_exp_f32 v130, v130
v_exp_f32 v131, v131
v_exp_f32 v132, v132
v_exp_f32 v133, v133
v_exp_f32 v134, v134
v_exp_f32 v135, v135
v_pk_mul_f32 v[96:97], v[96:97], v[104:105]
v_pk_mul_f32 v[98:99], v[98:99], v[106:107]
v_pk_mul_f32 v[100:101], v[100:101], v[108:109]
v_pk_mul_f32 v[102:103], v[102:103], v[110:111]
v_pk_add_f32 v[128:129], v[128:129], 1.0 op_sel_hi:[1,0]
v_pk_add_f32 v[130:131], v[130:131], 1.0 op_sel_hi:[1,0]
v_pk_add_f32 v[132:133], v[132:133], 1.0 op_sel_hi:[1,0]
v_pk_add_f32 v[134:135], v[134:135], 1.0 op_sel_hi:[1,0]
v_rcp_f32 v128, v128
v_rcp_f32 v129, v129
v_rcp_f32 v130, v130
v_rcp_f32 v131, v131
v_rcp_f32 v132, v132
v_rcp_f32 v133, v133
v_rcp_f32 v134, v134
v_rcp_f32 v135, v135
s_nop 0
v_pk_mul_f32 v[96:97], v[96:97], v[128:129]
v_pk_mul_f32 v[98:99], v[98:99], v[130:131]
v_pk_mul_f32 v[100:101], v[100:101], v[132:133]
v_pk_mul_f32 v[102:103], v[102:103], v[134:135]
v_cvt_pk_bf16_f32 v136, v96, v97
v_cvt_pk_bf16_f32 v137, v98, v99
v_cvt_pk_bf16_f32 v138, v100, v101
v_cvt_pk_bf16_f32 v139, v102, v103
buffer_store_dwordx4 v[136:139], v6, s[32:35], s40 offen sc0 sc1
s_add_u32 s40, s40, 512
s_nop 1
v_pk_mul_f32 v[112:113], v[112:113], v[208:209] op_sel_hi:[1,0]
v_pk_mul_f32 v[114:115], v[114:115], v[208:209] op_sel_hi:[1,0]
v_pk_mul_f32 v[116:117], v[116:117], v[208:209] op_sel_hi:[1,0]
v_pk_mul_f32 v[118:119], v[118:119], v[208:209] op_sel_hi:[1,0]
v_pk_mul_f32 v[120:121], v[120:121], v[208:209] op_sel_hi:[1,0]
v_pk_mul_f32 v[122:123], v[122:123], v[208:209] op_sel_hi:[1,0]
v_pk_mul_f32 v[124:125], v[124:125], v[208:209] op_sel_hi:[1,0]
v_pk_mul_f32 v[126:127], v[126:127], v[208:209] op_sel_hi:[1,0]
v_pk_mul_f32 v[128:129], v[112:113], v[112:113]
v_pk_fma_f32 v[128:129], v[128:129], s[52:53], v[210:211]
v_pk_mul_f32 v[128:129], v[128:129], v[112:113]
v_pk_mul_f32 v[130:131], v[114:115], v[114:115]
v_pk_fma_f32 v[130:131], v[130:131], s[52:53], v[210:211]
v_pk_mul_f32 v[130:131], v[130:131], v[114:115]
v_pk_mul_f32 v[132:133], v[116:117], v[116:117]
v_pk_fma_f32 v[132:133], v[132:133], s[52:53], v[210:211]
v_pk_mul_f32 v[132:133], v[132:133], v[116:117]
v_pk_mul_f32 v[134:135], v[118:119], v[118:119]
v_pk_fma_f32 v[134:135], v[134:135], s[52:53], v[210:211]
v_pk_mul_f32 v[134:135], v[134:135], v[118:119]
v_exp_f32 v128, v128
v_exp_f32 v129, v129
v_exp_f32 v130, v130
v_exp_f32 v131, v131
v_exp_f32 v132, v132
v_exp_f32 v133, v133
v_exp_f32 v134, v134
v_exp_f32 v135, v135
v_pk_mul_f32 v[112:113], v[112:113], v[120:121]
v_pk_mul_f32 v[114:115], v[114:115], v[122:123]
v_pk_mul_f32 v[116:117], v[116:117], v[124:125]
v_pk_mul_f32 v[118:119], v[118:119], v[126:127]
v_pk_add_f32 v[128:129], v[128:129], 1.0 op_sel_hi:[1,0]
v_pk_add_f32 v[130:131], v[130:131], 1.0 op_sel_hi:[1,0]
v_pk_add_f32 v[132:133], v[132:133], 1.0 op_sel_hi:[1,0]
v_pk_add_f32 v[134:135], v[134:135], 1.0 op_sel_hi:[1,0]
v_rcp_f32 v128, v128
v_rcp_f32 v129, v129
v_rcp_f32 v130, v130
v_rcp_f32 v131, v131
v_rcp_f32 v132, v132
v_rcp_f32 v133, v133
v_rcp_f32 v134, v134
v_rcp_f32 v135, v135
s_nop 0
v_pk_mul_f32 v[112:113], v[112:113], v[128:129]
v_pk_mul_f32 v[114:115], v[114:115], v[130:131]
v_pk_mul_f32 v[116:117], v[116:117], v[132:133]
v_pk_mul_f32 v[118:119], v[118:119], v[134:135]
v_cvt_pk_bf16_f32 v136, v112, v113
v_cvt_pk_bf16_f32 v137, v114, v115
v_cvt_pk_bf16_f32 v138, v116, v117
v_cvt_pk_bf16_f32 v139, v118, v119
buffer_store_dwordx4 v[136:139], v6, s[32:35], s40 offen sc0 sc1
s_add_u32 s40, s40, 512
s_nop 1
Lp3_exit:
s_endpgm
.globl p4_kernel
.p2align 8
.type p4_kernel,@function
p4_kernel:
s_cmp_ge_u32 s2, 256
s_cbranch_scc1 Lp4_exit
s_load_dwordx2 s[20:21], s[0:1], 64
s_load_dwordx2 s[24:25], s[0:1], 80
v_lshrrev_b32 v1, 6, v0
s_and_b32 s27, s2, 7
s_lshr_b32 s28, s2, 3
v_readfirstlane_b32 s26, v1
s_lshr_b32 s29, s27, 1
s_lshl_b32 s29, s29, 3
s_lshr_b32 s31, s28, 2
s_add_u32 s29, s29, s31
s_and_b32 s30, s27, 1
s_lshl_b32 s30, s30, 2
s_and_b32 s31, s28, 3
s_add_u32 s30, s30, s31
s_waitcnt lgkmcnt(0)
s_mov_b32 s32, s24
s_mov_b32 s33, s25
s_mov_b32 s34, 0x1600000
s_mov_b32 s35, 0x00020000
s_mov_b32 s36, s20
s_mov_b32 s37, s21
s_mov_b32 s38, 0x280000
s_mov_b32 s39, 0x00020000
s_cmp_lt_u32 s26, 4
s_cbranch_scc1 Lp4_cons
s_sub_u32 s26, s26, 4
s_cmp_lt_u32 s26, 2
s_cbranch_scc0 Lp4_ld1
v_and_b32 v1, 63, v0
v_lshlrev_b32 v2, 4, v1
s_and_b32 s40, s26, 1
s_mul_i32 s41, s30, 276480
s_mul_i32 s42, s40, 5120
s_add_u32 s41, s41, s42
s_add_u32 s41, s41, 10813440
s_mul_i32 s46, s40, 5120
s_mov_b32 s48, 0
s_add_u32 m0, s48, s46
s_nop 0
buffer_load_dwordx4 v2, s[32:35], s41 offen offset:0 lds
buffer_load_dwordx4 v2, s[32:35], s41 offen offset:1024 lds
buffer_load_dwordx4 v2, s[32:35], s41 offen offset:2048 lds
buffer_load_dwordx4 v2, s[32:35], s41 offen offset:3072 lds
s_add_u32 m0, m0, 4096
s_add_u32 s43, s41, 4096
buffer_load_dwordx4 v2, s[32:35], s43 offen lds
s_add_u32 s41, s41, 10240
s_add_u32 s48, s48, 18432
s_cmp_ge_u32 s48, 147456
s_cselect_b32 s48, 0, s48
s_add_u32 m0, s48, s46
s_nop 0
buffer_load_dwordx4 v2, s[32:35], s41 offen offset:0 lds
buffer_load_dwordx4 v2, s[32:35], s41 offen offset:1024 lds
buffer_load_dwordx4 v2, s[32:35], s41 offen offset:2048 lds
buffer_load_dwordx4 v2, s[32:35], s41 offen offset:3072 lds
s_add_u32 m0, m0, 4096
s_add_u32 s43, s41, 4096
buffer_load_dwordx4 v2, s[32:35], s43 offen lds
s_add_u32 s41, s41, 10240
s_add_u32 s48, s48, 18432
s_cmp_ge_u32 s48, 147456
s_cselect_b32 s48, 0, s48
s_add_u32 m0, s48, s46
s_nop 0
buffer_load_dwordx4 v2, s[32:35], s41 offen offset:0 lds
buffer_load_dwordx4 v2, s[32:35], s41 offen offset:1024 lds
buffer_load_dwordx4 v2, s[32:35], s41 offen offset:2048 lds
buffer_load_dwordx4 v2, s[32:35], s41 offen offset:3072 lds
s_add_u32 m0, m0, 4096
s_add_u32 s43, s41, 4096
buffer_load_dwordx4 v2, s[32:35], s43 offen lds
s_add_u32 s41, s41, 10240
s_add_u32 s48, s48, 18432
s_cmp_ge_u32 s48, 147456
s_cselect_b32 s48, 0, s48
s_waitcnt vmcnt(10)
s_barrier
s_add_u32 m0, s48, s46
s_nop 0
buffer_load_dwordx4 v2, s[32:35], s41 offen offset:0 lds
buffer_load_dwordx4 v2, s[32:35], s41 offen offset:1024 lds
buffer_load_dwordx4 v2, s[32:35], s41 offen offset:2048 lds
buffer_load_dwordx4 v2, s[32:35], s41 offen offset:3072 lds
s_add_u32 m0, m0, 4096
s_add_u32 s43, s41, 4096
buffer_load_dwordx4 v2, s[32:35], s43 offen lds
s_add_u32 s41, s41, 10240
s_add_u32 s48, s48, 18432
s_cmp_ge_u32 s48, 147456
s_cselect_b32 s48, 0, s48
s_add_u32 m0, s48, s46
s_nop 0
buffer_load_dwordx4 v2, s[32:35], s41 offen offset:0 lds
buffer_load_dwordx4 v2, s[32:35], s41 offen offset:1024 lds
buffer_load_dwordx4 v2, s[32:35], s41 offen offset:2048 lds
buffer_load_dwordx4 v2, s[32:35], s41 offen offset:3072 lds
s_add_u32 m0, m0, 4096
s_add_u32 s43, s41, 4096
buffer_load_dwordx4 v2, s[32:35], s43 offen lds
s_add_u32 s41, s41, 10240
s_add_u32 s48, s48, 18432
s_cmp_ge_u32 s48, 147456
s_cselect_b32 s48, 0, s48
s_waitcnt vmcnt(15)
s_barrier
s_add_u32 m0, s48, s46
s_nop 0
buffer_load_dwordx4 v2, s[32:35], s41 offen offset:0 lds
buffer_load_dwordx4 v2, s[32:35], s41 offen offset:1024 lds
buffer_load_dwordx4 v2, s[32:35], s41 offen offset:2048 lds
buffer_load_dwordx4 v2, s[32:35], s41 offen offset:3072 lds
s_add_u32 m0, m0, 4096
s_add_u32 s43, s41, 4096
buffer_load_dwordx4 v2, s[32:35], s43 offen lds
s_add_u32 s41, s41, 10240
s_add_u32 s48, s48, 18432
s_cmp_ge_u32 s48, 147456
s_cselect_b32 s48, 0, s48
s_add_u32 m0, s48, s46
s_nop 0
buffer_load_dwordx4 v2, s[32:35], s41 offen offset:0 lds
buffer_load_dwordx4 v2, s[32:35], s41 offen offset:1024 lds
buffer_load_dwordx4 v2, s[32:35], s41 offen offset:2048 lds
buffer_load_dwordx4 v2, s[32:35], s41 offen offset:3072 lds
s_add_u32 m0, m0, 4096
s_add_u32 s43, s41, 4096
buffer_load_dwordx4 v2, s[32:35], s43 offen lds
s_add_u32 s41, s41, 10240
s_add_u32 s48, s48, 18432
s_cmp_ge_u32 s48, 147456
s_cselect_b32 s48, 0, s48
s_waitcnt vmcnt(20)
s_barrier
s_add_u32 m0, s48, s46
s_nop 0
buffer_load_dwordx4 v2, s[32:35], s41 offen offset:0 lds
buffer_load_dwordx4 v2, s[32:35], s41 offen offset:1024 lds
buffer_load_dwordx4 v2, s[32:35], s41 offen offset:2048 lds
buffer_load_dwordx4 v2, s[32:35], s41 offen offset:3072 lds
s_add_u32 m0, m0, 4096
s_add_u32 s43, s41, 4096
buffer_load_dwordx4 v2, s[32:35], s43 offen lds
s_add_u32 s41, s41, 10240
s_add_u32 s48, s48, 18432
s_cmp_ge_u32 s48, 147456
s_cselect_b32 s48, 0, s48
s_add_u32 m0, s48, s46
s_nop 0
buffer_load_dwordx4 v2, s[32:35], s41 offen offset:0 lds
buffer_load_dwordx4 v2, s[32:35], s41 offen offset:1024 lds
buffer_load_dwordx4 v2, s[32:35], s41 offen offset:2048 lds
buffer_load_dwordx4 v2, s[32:35], s41 offen offset:3072 lds
s_add_u32 m0, m0, 4096
s_add_u32 s43, s41, 4096
buffer_load_dwordx4 v2, s[32:35], s43 offen lds
s_add_u32 s41, s41, 10240
s_add_u32 s48, s48, 18432
s_cmp_ge_u32 s48, 147456
s_cselect_b32 s48, 0, s48
s_waitcnt vmcnt(25)
s_barrier
s_add_u32 m0, s48, s46
s_nop 0
buffer_load_dwordx4 v2, s[32:35], s41 offen offset:0 lds
buffer_load_dwordx4 v2, s[32:35], s41 offen offset:1024 lds
buffer_load_dwordx4 v2, s[32:35], s41 offen offset:2048 lds
buffer_load_dwordx4 v2, s[32:35], s41 offen offset:3072 lds
s_add_u32 m0, m0, 4096
s_add_u32 s43, s41, 4096
buffer_load_dwordx4 v2, s[32:35], s43 offen lds
s_add_u32 s41, s41, 10240
s_add_u32 s48, s48, 18432
s_cmp_ge_u32 s48, 147456
s_cselect_b32 s48, 0, s48
s_add_u32 m0, s48, s46
s_nop 0
buffer_load_dwordx4 v2, s[32:35], s41 offen offset:0 lds
buffer_load_dwordx4 v2, s[32:35], s41 offen offset:1024 lds
buffer_load_dwordx4 v2, s[32:35], s41 offen offset:2048 lds
buffer_load_dwordx4 v2, s[32:35], s41 offen offset:3072 lds
s_add_u32 m0, m0, 4096
s_add_u32 s43, s41, 4096
buffer_load_dwordx4 v2, s[32:35], s43 offen lds
s_add_u32 s41, s41, 10240
s_add_u32 s48, s48, 18432
s_cmp_ge_u32 s48, 147456
s_cselect_b32 s48, 0, s48
s_mov_b32 s49, 3
Lp4ld_28:
s_waitcnt vmcnt(30)
s_barrier
s_add_u32 m0, s48, s46
s_nop 0
buffer_load_dwordx4 v2, s[32:35], s41 offen offset:0 lds
buffer_load_dwordx4 v2, s[32:35], s41 offen offset:1024 lds
buffer_load_dwordx4 v2, s[32:35], s41 offen offset:2048 lds
buffer_load_dwordx4 v2, s[32:35], s41 offen offset:3072 lds
s_add_u32 m0, m0, 4096
s_add_u32 s43, s41, 4096
buffer_load_dwordx4 v2, s[32:35], s43 offen lds
s_add_u32 s41, s41, 10240
s_add_u32 s48, s48, 18432
s_cmp_ge_u32 s48, 147456
s_cselect_b32 s48, 0, s48
s_add_u32 s49, s49, 1
s_cmp_lt_u32 s49, 19
s_cbranch_scc1 Lp4ld_28
s_waitcnt vmcnt(30)
s_barrier
s_waitcnt vmcnt(25)
s_barrier
s_waitcnt vmcnt(20)
s_barrier
s_waitcnt vmcnt(15)
s_barrier
s_waitcnt vmcnt(10)
s_barrier
s_waitcnt vmcnt(5)
s_barrier
s_waitcnt vmcnt(0)
s_barrier
s_waitcnt vmcnt(0)
s_barrier
s_branch Lp4_exit
Lp4_ld1:
v_and_b32 v1, 63, v0
v_lshlrev_b32 v2, 4, v1
s_and_b32 s40, s26, 1
v_add_u32 v4, 0, v2
v_add_u32 v5, 54272, v2
v_add_u32 v6, 108544, v2
v_add_u32 v7, 162816, v2
s_mul_i32 s41, s29, 221184
s_lshl_b32 s42, s40, 10
s_add_u32 s41, s41, s42
s_add_u32 s41, s41, 15728640
s_lshl_b32 s46, s40, 12
s_add_u32 s46, s46, 10240
s_mov_b32 s48, 0
s_add_u32 m0, s48, s46
s_nop 0
buffer_load_dwordx4 v4, s[32:35], s41 offen offset:0 lds
buffer_load_dwordx4 v5, s[32:35], s41 offen offset:1024 lds
buffer_load_dwordx4 v6, s[32:35], s41 offen offset:2048 lds
buffer_load_dwordx4 v7, s[32:35], s41 offen offset:3072 lds
s_add_u32 s41, s41, 2048
s_add_u32 s48, s48, 18432
s_cmp_ge_u32 s48, 147456
s_cselect_b32 s48, 0, s48
s_add_u32 m0, s48, s46
s_nop 0
buffer_load_dwordx4 v4, s[32:35], s41 offen offset:0 lds
buffer_load_dwordx4 v5, s[32:35], s41 offen offset:1024 lds
buffer_load_dwordx4 v6, s[32:35], s41 offen offset:2048 lds
buffer_load_dwordx4 v7, s[32:35], s41 offen offset:3072 lds
s_add_u32 s41, s41, 2048
s_add_u32 s48, s48, 18432
s_cmp_ge_u32 s48, 147456
s_cselect_b32 s48, 0, s48
s_add_u32 m0, s48, s46
s_nop 0
buffer_load_dwordx4 v4, s[32:35], s41 offen offset:0 lds
buffer_load_dwordx4 v5, s[32:35], s41 offen offset:1024 lds
buffer_load_dwordx4 v6, s[32:35], s41 offen offset:2048 lds
buffer_load_dwordx4 v7, s[32:35], s41 offen offset:3072 lds
s_add_u32 s41, s41, 2048
s_add_u32 s48, s48, 18432
s_cmp_ge_u32 s48, 147456
s_cselect_b32 s48, 0, s48
s_waitcnt vmcnt(8)
s_barrier
s_add_u32 m0, s48, s46
s_nop 0
buffer_load_dwordx4 v4, s[32:35], s41 offen offset:0 lds
buffer_load_dwordx4 v5, s[32:35], s41 offen offset:1024 lds
buffer_load_dwordx4 v6, s[32:35], s41 offen offset:2048 lds
buffer_load_dwordx4 v7, s[32:35], s41 offen offset:3072 lds
s_add_u32 s41, s41, 2048
s_add_u32 s48, s48, 18432
s_cmp_ge_u32 s48, 147456
s_cselect_b32 s48, 0, s48
s_add_u32 m0, s48, s46
s_nop 0
buffer_load_dwordx4 v4, s[32:35], s41 offen offset:0 lds
buffer_load_dwordx4 v5, s[32:35], s41 offen offset:1024 lds
buffer_load_dwordx4 v6, s[32:35], s41 offen offset:2048 lds
buffer_load_dwordx4 v7, s[32:35], s41 offen offset:3072 lds
s_add_u32 s41, s41, 2048
s_add_u32 s48, s48, 18432
s_cmp_ge_u32 s48, 147456
s_cselect_b32 s48, 0, s48
s_waitcnt vmcnt(12)
s_barrier
s_add_u32 m0, s48, s46
s_nop 0
buffer_load_dwordx4 v4, s[32:35], s41 offen offset:0 lds
buffer_load_dwordx4 v5, s[32:35], s41 offen offset:1024 lds
buffer_load_dwordx4 v6, s[32:35], s41 offen offset:2048 lds
buffer_load_dwordx4 v7, s[32:35], s41 offen offset:3072 lds
s_add_u32 s41, s41, 2048
s_add_u32 s48, s48, 18432
s_cmp_ge_u32 s48, 147456
s_cselect_b32 s48, 0, s48
s_add_u32 m0, s48, s46
s_nop 0
buffer_load_dwordx4 v4, s[32:35], s41 offen offset:0 lds
buffer_load_dwordx4 v5, s[32:35], s41 offen offset:1024 lds
buffer_load_dwordx4 v6, s[32:35], s41 offen offset:2048 lds
buffer_load_dwordx4 v7, s[32:35], s41 offen offset:3072 lds
s_add_u32 s41, s41, 2048
s_add_u32 s48, s48, 18432
s_cmp_ge_u32 s48, 147456
s_cselect_b32 s48, 0, s48
s_waitcnt vmcnt(16)
s_barrier
s_add_u32 m0, s48, s46
s_nop 0
buffer_load_dwordx4 v4, s[32:35], s41 offen offset:0 lds
buffer_load_dwordx4 v5, s[32:35], s41 offen offset:1024 lds
buffer_load_dwordx4 v6, s[32:35], s41 offen offset:2048 lds
buffer_load_dwordx4 v7, s[32:35], s41 offen offset:3072 lds
s_add_u32 s41, s41, 2048
s_add_u32 s48, s48, 18432
s_cmp_ge_u32 s48, 147456
s_cselect_b32 s48, 0, s48
s_add_u32 m0, s48, s46
s_nop 0
buffer_load_dwordx4 v4, s[32:35], s41 offen offset:0 lds
buffer_load_dwordx4 v5, s[32:35], s41 offen offset:1024 lds
buffer_load_dwordx4 v6, s[32:35], s41 offen offset:2048 lds
buffer_load_dwordx4 v7, s[32:35], s41 offen offset:3072 lds
s_add_u32 s41, s41, 2048
s_add_u32 s48, s48, 18432
s_cmp_ge_u32 s48, 147456
s_cselect_b32 s48, 0, s48
s_waitcnt vmcnt(20)
s_barrier
s_add_u32 m0, s48, s46
s_nop 0
buffer_load_dwordx4 v4, s[32:35], s41 offen offset:0 lds
buffer_load_dwordx4 v5, s[32:35], s41 offen offset:1024 lds
buffer_load_dwordx4 v6, s[32:35], s41 offen offset:2048 lds
buffer_load_dwordx4 v7, s[32:35], s41 offen offset:3072 lds
s_add_u32 s41, s41, 2048
s_add_u32 s48, s48, 18432
s_cmp_ge_u32 s48, 147456
s_cselect_b32 s48, 0, s48
s_add_u32 m0, s48, s46
s_nop 0
buffer_load_dwordx4 v4, s[32:35], s41 offen offset:0 lds
buffer_load_dwordx4 v5, s[32:35], s41 offen offset:1024 lds
buffer_load_dwordx4 v6, s[32:35], s41 offen offset:2048 lds
buffer_load_dwordx4 v7, s[32:35], s41 offen offset:3072 lds
s_add_u32 s41, s41, 2048
s_add_u32 s48, s48, 18432
s_cmp_ge_u32 s48, 147456
s_cselect_b32 s48, 0, s48
s_mov_b32 s49, 3
Lp4ld_29:
s_waitcnt vmcnt(24)
s_barrier
s_add_u32 m0, s48, s46
s_nop 0
buffer_load_dwordx4 v4, s[32:35], s41 offen offset:0 lds
buffer_load_dwordx4 v5, s[32:35], s41 offen offset:1024 lds
buffer_load_dwordx4 v6, s[32:35], s41 offen offset:2048 lds
buffer_load_dwordx4 v7, s[32:35], s41 offen offset:3072 lds
s_add_u32 s41, s41, 2048
s_add_u32 s48, s48, 18432
s_cmp_ge_u32 s48, 147456
s_cselect_b32 s48, 0, s48
s_add_u32 s49, s49, 1
s_cmp_lt_u32 s49, 19
s_cbranch_scc1 Lp4ld_29
s_waitcnt vmcnt(24)
s_barrier
s_waitcnt vmcnt(20)
s_barrier
s_waitcnt vmcnt(16)
s_barrier
s_waitcnt vmcnt(12)
s_barrier
s_waitcnt vmcnt(8)
s_barrier
s_waitcnt vmcnt(4)
s_barrier
s_waitcnt vmcnt(0)
s_barrier
s_waitcnt vmcnt(0)
s_barrier
s_branch Lp4_exit
Lp4_cons:
v_and_b32 v1, 63, v0
s_getpc_b64 s[70:71]
Lpc_30:
s_sub_u32 s70, s70, Lpc_30-p4_kernel
s_subb_u32 s71, s71, 0
v_lshlrev_b32 v3, 7, v1
v_min_u32 v3, Lp4_exit-p4_kernel-4, v3
global_load_dword v255, v3, s[70:71]
v_and_b32 v1, 63, v0
v_lshlrev_b32 v2, 4, v1
v_and_b32 v3, 15, v1
v_lshrrev_b32 v7, 4, v1
v_lshrrev_b32 v8, 1, v7
v_lshlrev_b32 v8, 5, v8
v_add_u32 v8, v8, v3
v_lshlrev_b32 v8, 4, v8
v_and_b32 v9, 1, v7
v_lshlrev_b32 v9, 3, v9
v_add_u32 v8, v8, v9
s_lshl_b32 s40, s29, 1
s_lshr_b32 s41, s26, 1
s_add_u32 s40, s40, s41
s_mul_i32 s40, s40, 40
s_mul_i32 s41, s30, 5
s_add_u32 s40, s40, s41
s_lshl_b32 s40, s40, 10
s_and_b32 s41, s26, 1
s_lshl_b32 s41, s41, 8
s_add_u32 s40, s40, s41
s_add_u32 s40, s40, 13041664
buffer_load_dwordx2 v[88:89], v8, s[32:35], s40 offen offset:0
buffer_load_dwordx2 v[90:91], v8, s[32:35], s40 offen offset:1024
buffer_load_dwordx2 v[92:93], v8, s[32:35], s40 offen offset:2048
buffer_load_dwordx2 v[94:95], v8, s[32:35], s40 offen offset:3072
s_add_u32 s40, s40, 4096
buffer_load_dwordx2 v[96:97], v8, s[32:35], s40 offen offset:0
v_mov_b32 v4, v2
s_lshl_b32 s41, s26, 10
s_add_u32 s41, s41, 10240
v_add_u32 v5, s41, v2
v_mov_b32 v16, 0
v_mov_b32 v17, 0
v_mov_b32 v18, 0
v_mov_b32 v19, 0
v_mov_b32 v20, 0
v_mov_b32 v21, 0
v_mov_b32 v22, 0
v_mov_b32 v23, 0
v_mov_b32 v24, 0
v_mov_b32 v25, 0
v_mov_b32 v26, 0
v_mov_b32 v27, 0
v_mov_b32 v28, 0
v_mov_b32 v29, 0
v_mov_b32 v30, 0
v_mov_b32 v31, 0
v_mov_b32 v32, 0
v_mov_b32 v33, 0
v_mov_b32 v34, 0
v_mov_b32 v35, 0
s_mov_b32 s42, 0
s_mov_b32 s44, 18432
s_mov_b32 s45, 4294838272
s_barrier
ds_read_b128 v[80:83], v5 offset:0
ds_read_b128 v[40:43], v4 offset:0
ds_read_b128 v[44:47], v4 offset:1024
ds_read_b128 v[48:51], v4 offset:2048
ds_read_b128 v[52:55], v4 offset:3072
ds_read_b128 v[56:59], v4 offset:4096
s_waitcnt lgkmcnt(0)
s_mov_b32 s47, 0
Lp4main_31:
v_mfma_f32_16x16x32_bf16 v[16:19], v[40:43], v[80:83], v[16:19]
ds_read_b128 v[84:87], v5 offset:4096
ds_read_b128 v[60:63], v4 offset:5120
v_mfma_f32_16x16x32_bf16 v[20:23], v[44:47], v[80:83], v[20:23]
ds_read_b128 v[64:67], v4 offset:6144
ds_read_b128 v[68:71], v4 offset:7168
v_mfma_f32_16x16x32_bf16 v[24:27], v[48:51], v[80:83], v[24:27]
ds_read_b128 v[72:75], v4 offset:8192
ds_read_b128 v[76:79], v4 offset:9216
v_mfma_f32_16x16x32_bf16 v[28:31], v[52:55], v[80:83], v[28:31]
v_mfma_f32_16x16x32_bf16 v[32:35], v[56:59], v[80:83], v[32:35]
s_add_u32 s42, s42, 18432
s_cmp_ge_u32 s42, 147456
s_cselect_b32 s43, s45, s44
s_cselect_b32 s42, 0, s42
v_add_u32 v4, s43, v4
v_add_u32 v5, s43, v5
s_waitcnt lgkmcnt(0)
s_barrier
v_mfma_f32_16x16x32_bf16 v[16:19], v[60:63], v[84:87], v[16:19]
ds_read_b128 v[80:83], v5 offset:0
ds_read_b128 v[40:43], v4 offset:0
v_mfma_f32_16x16x32_bf16 v[20:23], v[64:67], v[84:87], v[20:23]
ds_read_b128 v[44:47], v4 offset:1024
ds_read_b128 v[48:51], v4 offset:2048
v_mfma_f32_16x16x32_bf16 v[24:27], v[68:71], v[84:87], v[24:27]
ds_read_b128 v[52:55], v4 offset:3072
ds_read_b128 v[56:59], v4 offset:4096
v_mfma_f32_16x16x32_bf16 v[28:31], v[72:75], v[84:87], v[28:31]
v_mfma_f32_16x16x32_bf16 v[32:35], v[76:79], v[84:87], v[32:35]
s_waitcnt lgkmcnt(0)
s_add_u32 s47, s47, 1
s_cmp_lt_u32 s47, 27
s_cbranch_scc1 Lp4main_31
s_waitcnt vmcnt(0)
s_nop 7
v_lshlrev_b32 v60, 16, v88
v_and_b32 v61, 0xffff0000, v88
v_pk_add_f32 v[60:61], v[60:61], v[16:17]
v_cvt_pk_bf16_f32 v100, v60, v61
v_lshlrev_b32 v60, 16, v89
v_and_b32 v61, 0xffff0000, v89
v_pk_add_f32 v[60:61], v[60:61], v[18:19]
v_cvt_pk_bf16_f32 v101, v60, v61
v_lshlrev_b32 v60, 16, v90
v_and_b32 v61, 0xffff0000, v90
v_pk_add_f32 v[60:61], v[60:61], v[20:21]
v_cvt_pk_bf16_f32 v102, v60, v61
v_lshlrev_b32 v60, 16, v91
v_and_b32 v61, 0xffff0000, v91
v_pk_add_f32 v[60:61], v[60:61], v[22:23]
v_cvt_pk_bf16_f32 v103, v60, v61
v_lshlrev_b32 v60, 16, v92
v_and_b32 v61, 0xffff0000, v92
v_pk_add_f32 v[60:61], v[60:61], v[24:25]
v_cvt_pk_bf16_f32 v104, v60, v61
v_lshlrev_b32 v60, 16, v93
v_and_b32 v61, 0xffff0000, v93
v_pk_add_f32 v[60:61], v[60:61], v[26:27]
v_cvt_pk_bf16_f32 v105, v60, v61
v_lshlrev_b32 v60, 16, v94
v_and_b32 v61, 0xffff0000, v94
v_pk_add_f32 v[60:61], v[60:61], v[28:29]
v_cvt_pk_bf16_f32 v106, v60, v61
v_lshlrev_b32 v60, 16, v95
v_and_b32 v61, 0xffff0000, v95
v_pk_add_f32 v[60:61], v[60:61], v[30:31]
v_cvt_pk_bf16_f32 v107, v60, v61
v_lshlrev_b32 v60, 16, v96
v_and_b32 v61, 0xffff0000, v96
v_pk_add_f32 v[60:61], v[60:61], v[32:33]
v_cvt_pk_bf16_f32 v108, v60, v61
v_lshlrev_b32 v60, 16, v97
v_and_b32 v61, 0xffff0000, v97
v_pk_add_f32 v[60:61], v[60:61], v[34:35]
v_cvt_pk_bf16_f32 v109, v60, v61
v_mul_u32_u24 v8, 176, v3
v_lshlrev_b32 v9, 3, v7
v_add_u32 v8, v8, v9
s_mul_i32 s40, s26, 2816
s_add_u32 s40, s40, 147456
v_add_u32 v8, s40, v8
ds_write_b64 v8, v[100:101] offset:0
ds_write_b64 v8, v[102:103] offset:32
ds_write_b64 v8, v[104:105] offset:64
ds_write_b64 v8, v[106:107] offset:96
ds_write_b64 v8, v[108:109] offset:128
v_add_u32 v10, 0, v1
v_mul_u32_u24 v11, 205, v10
v_lshrrev_b32 v11, 11, v11
v_mul_u32_u24 v12, 10, v11
v_sub_u32 v12, v10, v12
v_lshlrev_b32 v12, 4, v12
v_mul_u32_u24 v13, 176, v11
v_add_u32 v13, v13, v12
v_add_u32 v20, s40, v13
v_mul_u32_u24 v13, 1280, v11
v_add_u32 v24, v13, v12
v_add_u32 v10, 64, v1
v_mul_u32_u24 v11, 205, v10
v_lshrrev_b32 v11, 11, v11
v_mul_u32_u24 v12, 10, v11
v_sub_u32 v12, v10, v12
v_lshlrev_b32 v12, 4, v12
v_mul_u32_u24 v13, 176, v11
v_add_u32 v13, v13, v12
v_add_u32 v21, s40, v13
v_mul_u32_u24 v13, 1280, v11
v_add_u32 v25, v13, v12
v_add_u32 v10, 128, v1
v_mul_u32_u24 v11, 205, v10
v_lshrrev_b32 v11, 11, v11
v_mul_u32_u24 v12, 10, v11
v_sub_u32 v12, v10, v12
v_lshlrev_b32 v12, 4, v12
v_mul_u32_u24 v13, 176, v11
v_add_u32 v13, v13, v12
v_add_u32 v22, s40, v13
v_mul_u32_u24 v13, 1280, v11
v_add_u32 v26, v13, v12
s_waitcnt lgkmcnt(0)
ds_read_b128 v[40:43], v20
ds_read_b128 v[44:47], v21
ds_read_b128 v[48:51], v22
s_lshl_b32 s41, s29, 6
s_lshl_b32 s42, s26, 4
s_add_u32 s41, s41, s42
s_mul_i32 s41, s41, 1280
s_mul_i32 s42, s30, 160
s_add_u32 s41, s41, s42
s_waitcnt lgkmcnt(0)
buffer_store_dwordx4 v[40:43], v24, s[36:39], s41 offen
buffer_store_dwordx4 v[44:47], v25, s[36:39], s41 offen
s_mov_b32 exec_hi, 0
buffer_store_dwordx4 v[48:51], v26, s[36:39], s41 offen
s_mov_b64 exec, -1
Lp4_exit:
s_endpgm
Lcode_end:
s_endpgm
.section .rodata,"a"
.p2align 6
Lkd_start:
.p2align 6
.amdhsa_kernel p1_kernel
  .amdhsa_next_free_vgpr 256
  .amdhsa_next_free_sgpr 102
  .amdhsa_accum_offset 256
  .amdhsa_group_segment_fixed_size 0
  .amdhsa_kernarg_size 88
  .amdhsa_user_sgpr_count 2
  .amdhsa_user_sgpr_kernarg_segment_ptr 1
  .amdhsa_system_sgpr_workgroup_id_x 1
.end_amdhsa_kernel
.p2align 6
.amdhsa_kernel p2_kernel
  .amdhsa_next_free_vgpr 512
  .amdhsa_next_free_sgpr 102
  .amdhsa_accum_offset 256
  .amdhsa_group_segment_fixed_size 0
  .amdhsa_kernarg_size 88
  .amdhsa_user_sgpr_count 2
  .amdhsa_user_sgpr_kernarg_segment_ptr 1
  .amdhsa_system_sgpr_workgroup_id_x 1
.end_amdhsa_kernel
.p2align 6
.amdhsa_kernel p3_kernel
  .amdhsa_next_free_vgpr 256
  .amdhsa_next_free_sgpr 102
  .amdhsa_accum_offset 256
  .amdhsa_group_segment_fixed_size 0
  .amdhsa_kernarg_size 88
  .amdhsa_user_sgpr_count 2
  .amdhsa_user_sgpr_kernarg_segment_ptr 1
  .amdhsa_system_sgpr_workgroup_id_x 1
.end_amdhsa_kernel
.p2align 6
.amdhsa_kernel p4_kernel
  .amdhsa_next_free_vgpr 256
  .amdhsa_next_free_sgpr 102
  .amdhsa_accum_offset 256
  .amdhsa_group_segment_fixed_size 0
  .amdhsa_kernarg_size 88
  .amdhsa_user_sgpr_count 2
  .amdhsa_user_sgpr_kernarg_segment_ptr 1
  .amdhsa_system_sgpr_workgroup_id_x 1
.end_amdhsa_kernel
```
